```python
import torch

def _softmax(x, axis=-1):
    return torch.softmax(x, dim=axis)
def _gelu(x):
    return torch.nn.functional.gelu(x, approximate="tanh")
def _silu(x):
    return torch.nn.functional.silu(x)
def _sigmoid(x):
    return torch.sigmoid(x)
def _layernorm(x, axis=-1, eps=1e-5):
    m = x.mean(dim=axis, keepdim=True)
    v = x.var(dim=axis, keepdim=True, unbiased=False)
    return (x - m) / torch.sqrt(v + eps)
def _scatter_add(tgt, idx, src, axis=0):
    return tgt.clone().index_add_(axis, idx, src)
def _segment_sum(src, seg, n):
    out = torch.zeros((n,) + src.shape[1:], dtype=src.dtype)
    return out.index_add_(0, seg, src)
def _pad(x, pw):
    flat = tuple(v for pair in reversed(pw) for v in pair)
    return torch.nn.functional.pad(x, flat)

kernel_name = 'recurrent_scan__linear_attn_block__mixer_s_mlp__prompt'

def setup_inputs():

    _w = (lambda a: (lambda t: t.to(torch.bfloat16) if t.is_floating_point() else t)(torch.as_tensor(a)))
    def _A_setup():
        B, S, D = 1, 2048, 512
        return {
            "x": _w((lambda *s: torch.randn(*s, dtype=torch.bfloat16) * 0.05)(B, S, D)),
            "wqkv": _w((lambda *s: torch.randn(*s, dtype=torch.bfloat16) * 0.05)(D, 3 * D)),
            "wo": _w((lambda *s: torch.randn(*s, dtype=torch.bfloat16) * 0.05)(D, D)),
        }
    _A_in = _A_setup()

    def _B_setup():
        B, S, D, F = 1, 2048, 512, 1792
        return {
            "x":  _w((lambda *s: torch.randn(*s, dtype=torch.bfloat16) * 0.05)(B, S, D)),
            "w1": _w((lambda *s: torch.randn(*s, dtype=torch.bfloat16) * 3.2)(D, D) * (D ** -0.5)),
            "w2": _w((lambda *s: torch.randn(*s, dtype=torch.bfloat16) * 3.2)(D, D) * (D ** -0.5)),
            "w3": _w((lambda *s: torch.randn(*s, dtype=torch.bfloat16) * 3.2)(D, F) * (D ** -0.5)),
            "w4": _w((lambda *s: torch.randn(*s, dtype=torch.bfloat16) * 1.6)(F, D) * (F ** -0.5)),
        }
    _B_in = _B_setup()

    return {
        "A_x": _A_in["x"],
        "A_wqkv": _A_in["wqkv"],
        "A_wo": _A_in["wo"],
        "B_x": _B_in["x"],
        "B_w1": _B_in["w1"],
        "B_w2": _B_in["w2"],
        "B_w3": _B_in["w3"],
        "B_w4": _B_in["w4"],
    }

def reference(A_x, A_wqkv, A_wo, B_x, B_w1, B_w2, B_w3, B_w4):
    def _A_ref(x, wqkv, wo):
        B, S, D = x.shape
        H = 32; Dh = D // H
        qkv = (lambda x, *d: x.permute(*d))((x @ wqkv).reshape(B, S, 3, H, Dh), 2, 0, 3, 1, 4)
        q, k, v = qkv[0], qkv[1], qkv[2]
        phi = lambda t: torch.where(t > 0, t + 1, torch.exp(t)) + 1e-6
        pq, pk = phi(q), phi(k)
        kv = torch.einsum("bhsd,bhse->bhde", pk, v)
        z = torch.einsum("bhsd->bhd", pk)
        num = torch.einsum("bhqd,bhde->bhqe", pq, kv)
        den = torch.einsum("bhqd,bhd->bhq", pq, z)[..., None] + 1e-6
        o = num / den
        return (lambda x, *d: x.permute(*d))(o, 0, 2, 1, 3).reshape(B, S, D) @ wo

    def _B_ref(x, w1, w2, w3, w4):
        B, S, D = x.shape
        h = _gelu(_layernorm(x, axis=-1) @ w1)
        c = D // 4
        g0 = _pad(h[:, :, 0*c:1*c], ((0, 0), (1, 0), (0, 0)))[:, :S, :]
        g1 = _pad(h[:, :, 1*c:2*c], ((0, 0), (0, 1), (0, 0)))[:, 1:, :]
        g2 = _pad(h[:, :, 2*c:3*c], ((0, 0), (2, 0), (0, 0)))[:, :S, :]
        g3 = _pad(h[:, :, 3*c:   ], ((0, 0), (0, 2), (0, 0)))[:, 2:, :]
        hs = torch.concatenate([g0, g1, g2, g3], axis=-1) @ w2
        x1 = x + hs
        h2 = _gelu(_layernorm(x1, axis=-1) @ w3) @ w4
        return x1 + h2

    x = A_x
    xn = _layernorm(x, axis=-1)
    s = _A_ref(xn, A_wqkv, A_wo)
    g = _silu(_B_ref(xn, B_w1, B_w2, B_w3, B_w4))
    return x + s * g
```

```asm
; @launch grid=(256,1,1) block=(512,1,1) lds=163840
.amdgcn_target "amdgcn-amd-amdhsa--gfx950"
.text
.globl recurrent_scan__linear_attn_block__mixer_s_mlp__prompt_kernel
.p2align 8
.type recurrent_scan__linear_attn_block__mixer_s_mlp__prompt_kernel,@function
recurrent_scan__linear_attn_block__mixer_s_mlp__prompt_kernel:
  s_cmp_ge_u32 s2, 256
  s_cbranch_scc1 P_END
  s_load_dwordx16 s[4:19], s[0:1], 0
  s_load_dwordx4 s[20:23], s[0:1], 64
  s_load_dwordx2 s[24:25], s[0:1], 80
  s_lshr_b32 s74, s2, 3
  s_lshl_b32 s74, s74, 4
  v_lshrrev_b32 v28, 6, v0
  v_lshlrev_b32 v28, 1, v28
  v_and_b32 v29, 63, v0
  v_min_u32 v29, 1, v29
  v_add3_u32 v28, v28, v29, s74
  v_lshlrev_b32 v28, 7, v28
  s_getpc_b64 s[72:73]
CPF_L:
  v_min_u32 v28, P_END-CPF_L, v28
  v_mov_b32 v29, s73
  v_add_co_u32 v28, vcc, s72, v28
  s_nop 1
  v_addc_co_u32 v29, vcc, 0, v29, vcc
  global_load_dword v254, v[28:29], off
  v_lshrrev_b32 v1, 6, v0
  v_and_b32 v0, 63, v0
  v_mov_b32 v3, 0
  v_readfirstlane_b32 s26, v1
  s_and_b32 s72, s2, 7
  s_lshr_b32 s73, s2, 3
  s_lshr_b32 s74, s72, 1
  s_lshl_b32 s74, s74, 3
  s_lshr_b32 s75, s73, 2
  s_add_u32 s27, s74, s75
  s_and_b32 s74, s72, 1
  s_lshl_b32 s74, s74, 2
  s_and_b32 s75, s73, 3
  s_add_u32 s28, s74, s75
  s_and_b32 s30, s26, 1
  s_bfe_u32 s31, s26, 0x10001
  s_mov_b32 s78, 65536
  v_and_b32 v1, 31, v0
  v_lshrrev_b32 v2, 5, v0
  s_and_b32 s84, s2, 7
  s_lshr_b32 s85, s2, 3
  v_lshrrev_b32 v6, 4, v0
  v_and_b32 v7, 15, v0
  s_lshl_b32 s72, s26, 3
  v_add_u32 v6, s72, v6
  v_lshrrev_b32 v9, 3, v7
  v_lshlrev_b32 v9, 13, v9
  v_and_b32 v10, 7, v7
  v_add_u32 v8, 0, v6
  v_bfe_u32 v11, v8, 1, 3
  v_xor_b32 v11, v10, v11
  v_lshl_add_u32 v11, v11, 4, v9
  v_lshl_add_u32 v61, v8, 7, v11
  v_add_u32 v8, 4, v6
  v_bfe_u32 v11, v8, 1, 3
  v_xor_b32 v11, v10, v11
  v_lshl_add_u32 v11, v11, 4, v9
  v_lshl_add_u32 v62, v8, 7, v11
  v_lshlrev_b32 v58, 4, v6
  v_add_u32 v58, 155648, v58
  s_lshl_b32 s72, s27, 6
  v_add_u32 v6, s72, v6
  v_lshlrev_b32 v6, 10, v6
  v_lshl_add_u32 v60, v7, 4, v6
  s_movk_i32 s71, 0x1000
  v_mov_b32 v128, 0x3f803f80
  v_mov_b32 v59, 0
  s_cmp_ge_u32 s26, 4
  s_cbranch_scc1 B_PRE
  s_waitcnt lgkmcnt(0)
  s_mov_b32 s32, s4
  s_mov_b32 s33, s5
  s_mov_b32 s34, 0x200000
  s_mov_b32 s35, 0x00020000
  buffer_load_dwordx4 v[64:67], v60, s[32:35], 0 offen offset:0
  buffer_load_dwordx4 v[68:71], v60, s[32:35], 0 offen offset:256
  buffer_load_dwordx4 v[72:75], v60, s[32:35], 0 offen offset:512
  buffer_load_dwordx4 v[76:79], v60, s[32:35], 0 offen offset:768
  buffer_load_dwordx4 v[80:83], v60, s[32:35], s71 offen offset:0
  buffer_load_dwordx4 v[84:87], v60, s[32:35], s71 offen offset:256
  buffer_load_dwordx4 v[88:91], v60, s[32:35], s71 offen offset:512
  buffer_load_dwordx4 v[92:95], v60, s[32:35], s71 offen offset:768
  s_mov_b32 s68, s22
  s_mov_b32 s69, s23
  s_mov_b32 s70, 0x100
  s_mov_b32 s71, 0x00020000
  s_or_b32 s73, s2, s26
  s_cmp_lg_u32 s73, 0
  s_cbranch_scc1 P_NON
  s_memrealtime s[74:75]
  v_mov_b32 v6, 0
  s_waitcnt lgkmcnt(0)
  s_or_b32 s74, s74, 1
  v_mov_b32 v7, s74
  s_mov_b64 exec, 1
  buffer_store_dword v7, v6, s[68:71], 0 offen sc1
  s_mov_b64 exec, -1
P_NON:
  buffer_load_dword v63, v59, s[68:71], 0 offen sc1
  s_mov_b32 s60, s24
  s_mov_b32 s61, s25
  s_mov_b32 s62, 0x2800000
  s_mov_b32 s63, 0x00020000
  s_mov_b32 s64, s20
  s_mov_b32 s65, s21
  s_mov_b32 s66, 0x200000
  s_mov_b32 s67, 0x00020000
  v_bfe_u32 v3, v0, 2, 2
  v_and_b32 v4, 3, v0
  v_bfe_u32 v5, v0, 4, 1
  s_lshl_b32 s72, s31, 2
  v_lshrrev_b32 v30, 1, v4
  v_lshl_add_u32 v30, v5, 1, v30
  v_add_u32 v30, s72, v30
  v_lshrrev_b32 v31, 1, v3
  v_lshlrev_b32 v31, 2, v31
  v_xor_b32 v30, v30, v31
  v_lshlrev_b32 v30, 4, v30
  v_and_b32 v31, 1, v4
  v_lshl_add_u32 v30, v31, 3, v30
  v_lshl_add_u32 v31, v2, 3, v3
  v_lshl_add_u32 v6, v31, 7, v30
  v_add_u32 v7, 0x10000, v6
  v_lshl_add_u32 v31, v2, 2, v3
  v_lshl_add_u32 v8, v31, 7, v30
  v_add_u32 v9, 0x10000, v8
  v_lshlrev_b32 v21, 4, v0
  s_lshl_b32 s72, s30, 12
  s_add_u32 s72, s72, 8192
  v_add_u32 v10, s72, v21
  v_add_u32 v11, 0x10000, v10
  v_bfe_u32 v30, v1, 1, 3
  v_xor_b32 v30, v30, v2
  v_lshlrev_b32 v30, 4, v30
  v_lshl_add_u32 v12, v1, 7, v30
  s_lshl_b32 s72, s30, 12
  v_add_u32 v12, s72, v12
  v_xor_b32 v13, 32, v12
  v_xor_b32 v14, 64, v12
  v_xor_b32 v15, 96, v12
  s_lshl_b32 s72, s30, 14
  s_add_u32 s72, s72, 0x10000
  v_add_u32 v16, s72, v21
  s_lshl_b32 s72, s26, 12
  s_add_u32 s72, s72, 131072
  v_add_u32 v17, s72, v21
  s_lshl_b32 s72, s30, 5
  v_add_u32 v30, s72, v1
  v_bfe_u32 v31, v30, 1, 3
  s_lshl_b32 s72, s31, 2
  v_xor_b32 v31, s72, v31
  v_lshlrev_b32 v31, 4, v31
  v_lshl_add_u32 v31, v30, 7, v31
  v_lshl_add_u32 v31, v2, 3, v31
  v_add_u32 v18, 147456, v31
  v_mov_b32 v20, 0x7f000000
  v_mov_b32 v30, 0
  v_cmp_eq_u32 vcc, 0, v0
  s_nop 1
  v_cndmask_b32 v20, v20, v30, vcc
  v_lshlrev_b32 v3, 2, v0
  v_mov_b32 v30, 0x3f803f80
  s_lshl_b32 s4, s28, 2
  s_lshl_b32 s72, s31, 1
  s_add_u32 s4, s4, s72
  s_and_b32 s72, s28, 3
  s_cmp_eq_u32 s72, 3
  s_cselect_b32 s3, 16, 0
  s_lshl_b32 s6, s27, 1
  s_add_u32 s6, s6, s30
  s_lshl_b32 s72, s6, 15
  s_lshl_b32 s73, s4, 10
  s_add_u32 s7, s72, s73
  s_lshl_b32 s8, s27, 5
  s_lshl_b32 s72, s28, 2
  s_add_u32 s8, s8, s72
  s_add_u32 s8, s8, s26
  s_lshl_b32 s8, s8, 2
  s_waitcnt vmcnt(5)
  v_dot2_f32_bf16 v130, v64, v128, 0
  v_dot2_f32_bf16 v132, v64, v64, 0
  v_dot2_f32_bf16 v131, v65, v128, 0
  v_dot2_f32_bf16 v133, v65, v65, 0
  v_dot2_f32_bf16 v130, v66, v128, v130
  v_dot2_f32_bf16 v132, v66, v66, v132
  v_dot2_f32_bf16 v131, v67, v128, v131
  v_dot2_f32_bf16 v133, v67, v67, v133
  v_dot2_f32_bf16 v130, v68, v128, v130
  v_dot2_f32_bf16 v132, v68, v68, v132
  v_dot2_f32_bf16 v131, v69, v128, v131
  v_dot2_f32_bf16 v133, v69, v69, v133
  v_dot2_f32_bf16 v130, v70, v128, v130
  v_dot2_f32_bf16 v132, v70, v70, v132
  v_dot2_f32_bf16 v131, v71, v128, v131
  v_dot2_f32_bf16 v133, v71, v71, v133
  v_dot2_f32_bf16 v130, v72, v128, v130
  v_dot2_f32_bf16 v132, v72, v72, v132
  v_dot2_f32_bf16 v131, v73, v128, v131
  v_dot2_f32_bf16 v133, v73, v73, v133
  v_dot2_f32_bf16 v130, v74, v128, v130
  v_dot2_f32_bf16 v132, v74, v74, v132
  v_dot2_f32_bf16 v131, v75, v128, v131
  v_dot2_f32_bf16 v133, v75, v75, v133
  v_dot2_f32_bf16 v130, v76, v128, v130
  v_dot2_f32_bf16 v132, v76, v76, v132
  v_dot2_f32_bf16 v131, v77, v128, v131
  v_dot2_f32_bf16 v133, v77, v77, v133
  v_dot2_f32_bf16 v130, v78, v128, v130
  v_dot2_f32_bf16 v132, v78, v78, v132
  v_dot2_f32_bf16 v131, v79, v128, v131
  v_dot2_f32_bf16 v133, v79, v79, v133
  v_lshlrev_b32 v144, 16, v64
  v_and_b32 v145, 0xffff0000, v64
  v_lshlrev_b32 v146, 16, v65
  v_and_b32 v147, 0xffff0000, v65
  v_lshlrev_b32 v148, 16, v66
  v_and_b32 v149, 0xffff0000, v66
  v_lshlrev_b32 v150, 16, v67
  v_and_b32 v151, 0xffff0000, v67
  v_lshlrev_b32 v152, 16, v68
  v_and_b32 v153, 0xffff0000, v68
  v_lshlrev_b32 v154, 16, v69
  v_and_b32 v155, 0xffff0000, v69
  v_lshlrev_b32 v156, 16, v70
  v_and_b32 v157, 0xffff0000, v70
  v_lshlrev_b32 v158, 16, v71
  v_and_b32 v159, 0xffff0000, v71
  v_add_f32 v130, v130, v131
  v_add_f32 v132, v132, v133
  s_nop 0
  v_add_f32_dpp v130, v130, v130 quad_perm:[1,0,3,2] row_mask:0xf bank_mask:0xf
  v_add_f32_dpp v132, v132, v132 quad_perm:[1,0,3,2] row_mask:0xf bank_mask:0xf
  s_nop 0
  v_add_f32_dpp v130, v130, v130 quad_perm:[2,3,0,1] row_mask:0xf bank_mask:0xf
  v_add_f32_dpp v132, v132, v132 quad_perm:[2,3,0,1] row_mask:0xf bank_mask:0xf
  s_nop 0
  v_add_f32_dpp v130, v130, v130 row_half_mirror row_mask:0xf bank_mask:0xf
  v_add_f32_dpp v132, v132, v132 row_half_mirror row_mask:0xf bank_mask:0xf
  s_nop 0
  v_add_f32_dpp v130, v130, v130 row_mirror row_mask:0xf bank_mask:0xf
  v_add_f32_dpp v132, v132, v132 row_mirror row_mask:0xf bank_mask:0xf
  v_mul_f32 v130, 0x3b000000, v130
  v_mul_f32 v132, 0x3b000000, v132
  v_fma_f32 v132, -v130, v130, v132
  v_max_f32 v132, 0, v132
  v_add_f32 v133, 0x3727c5ac, v132
  v_rsq_f32 v137, v133
  v_mov_b32 v139, 0
  v_mul_f32 v136, v130, v137
  v_sub_f32 v136, 0, v136
  v_mul_f32 v138, v137, v137
  v_mul_f32 v138, v138, v132
  v_add_f32 v138, 0x3727c5ac, v138
  v_rsq_f32 v138, v138
  v_pk_fma_f32 v[144:145], v[144:145], v[136:137], v[136:137] op_sel:[0,1,0] op_sel_hi:[1,1,0]
  v_pk_fma_f32 v[146:147], v[146:147], v[136:137], v[136:137] op_sel:[0,1,0] op_sel_hi:[1,1,0]
  v_pk_fma_f32 v[148:149], v[148:149], v[136:137], v[136:137] op_sel:[0,1,0] op_sel_hi:[1,1,0]
  v_pk_fma_f32 v[150:151], v[150:151], v[136:137], v[136:137] op_sel:[0,1,0] op_sel_hi:[1,1,0]
  v_cvt_pk_bf16_f32 v64, v144, v145
  v_cvt_pk_bf16_f32 v65, v146, v147
  v_cvt_pk_bf16_f32 v66, v148, v149
  v_cvt_pk_bf16_f32 v67, v150, v151
  ds_write_b128 v61, v[64:67] offset:0
  v_pk_fma_f32 v[152:153], v[152:153], v[136:137], v[136:137] op_sel:[0,1,0] op_sel_hi:[1,1,0]
  v_pk_fma_f32 v[154:155], v[154:155], v[136:137], v[136:137] op_sel:[0,1,0] op_sel_hi:[1,1,0]
  v_pk_fma_f32 v[156:157], v[156:157], v[136:137], v[136:137] op_sel:[0,1,0] op_sel_hi:[1,1,0]
  v_pk_fma_f32 v[158:159], v[158:159], v[136:137], v[136:137] op_sel:[0,1,0] op_sel_hi:[1,1,0]
  v_cvt_pk_bf16_f32 v68, v152, v153
  v_cvt_pk_bf16_f32 v69, v154, v155
  v_cvt_pk_bf16_f32 v70, v156, v157
  v_cvt_pk_bf16_f32 v71, v158, v159
  ds_write_b128 v61, v[68:71] offset:16384
  v_lshlrev_b32 v144, 16, v72
  v_and_b32 v145, 0xffff0000, v72
  v_lshlrev_b32 v146, 16, v73
  v_and_b32 v147, 0xffff0000, v73
  v_lshlrev_b32 v148, 16, v74
  v_and_b32 v149, 0xffff0000, v74
  v_lshlrev_b32 v150, 16, v75
  v_and_b32 v151, 0xffff0000, v75
  v_pk_fma_f32 v[144:145], v[144:145], v[136:137], v[136:137] op_sel:[0,1,0] op_sel_hi:[1,1,0]
  v_pk_fma_f32 v[146:147], v[146:147], v[136:137], v[136:137] op_sel:[0,1,0] op_sel_hi:[1,1,0]
  v_pk_fma_f32 v[148:149], v[148:149], v[136:137], v[136:137] op_sel:[0,1,0] op_sel_hi:[1,1,0]
  v_pk_fma_f32 v[150:151], v[150:151], v[136:137], v[136:137] op_sel:[0,1,0] op_sel_hi:[1,1,0]
  v_cvt_pk_bf16_f32 v72, v144, v145
  v_cvt_pk_bf16_f32 v73, v146, v147
  v_cvt_pk_bf16_f32 v74, v148, v149
  v_cvt_pk_bf16_f32 v75, v150, v151
  ds_write_b128 v61, v[72:75] offset:32768
  v_lshlrev_b32 v152, 16, v76
  v_and_b32 v153, 0xffff0000, v76
  v_lshlrev_b32 v154, 16, v77
  v_and_b32 v155, 0xffff0000, v77
  v_lshlrev_b32 v156, 16, v78
  v_and_b32 v157, 0xffff0000, v78
  v_lshlrev_b32 v158, 16, v79
  v_and_b32 v159, 0xffff0000, v79
  v_pk_fma_f32 v[152:153], v[152:153], v[136:137], v[136:137] op_sel:[0,1,0] op_sel_hi:[1,1,0]
  v_pk_fma_f32 v[154:155], v[154:155], v[136:137], v[136:137] op_sel:[0,1,0] op_sel_hi:[1,1,0]
  v_pk_fma_f32 v[156:157], v[156:157], v[136:137], v[136:137] op_sel:[0,1,0] op_sel_hi:[1,1,0]
  v_pk_fma_f32 v[158:159], v[158:159], v[136:137], v[136:137] op_sel:[0,1,0] op_sel_hi:[1,1,0]
  v_cvt_pk_bf16_f32 v76, v152, v153
  v_cvt_pk_bf16_f32 v77, v154, v155
  v_cvt_pk_bf16_f32 v78, v156, v157
  v_cvt_pk_bf16_f32 v79, v158, v159
  ds_write_b128 v61, v[76:79] offset:49152
  ds_write_b128 v58, v[136:139] offset:0
  s_waitcnt vmcnt(1)
  v_dot2_f32_bf16 v130, v80, v128, 0
  v_dot2_f32_bf16 v132, v80, v80, 0
  v_dot2_f32_bf16 v131, v81, v128, 0
  v_dot2_f32_bf16 v133, v81, v81, 0
  v_dot2_f32_bf16 v130, v82, v128, v130
  v_dot2_f32_bf16 v132, v82, v82, v132
  v_dot2_f32_bf16 v131, v83, v128, v131
  v_dot2_f32_bf16 v133, v83, v83, v133
  v_dot2_f32_bf16 v130, v84, v128, v130
  v_dot2_f32_bf16 v132, v84, v84, v132
  v_dot2_f32_bf16 v131, v85, v128, v131
  v_dot2_f32_bf16 v133, v85, v85, v133
  v_dot2_f32_bf16 v130, v86, v128, v130
  v_dot2_f32_bf16 v132, v86, v86, v132
  v_dot2_f32_bf16 v131, v87, v128, v131
  v_dot2_f32_bf16 v133, v87, v87, v133
  v_dot2_f32_bf16 v130, v88, v128, v130
  v_dot2_f32_bf16 v132, v88, v88, v132
  v_dot2_f32_bf16 v131, v89, v128, v131
  v_dot2_f32_bf16 v133, v89, v89, v133
  v_dot2_f32_bf16 v130, v90, v128, v130
  v_dot2_f32_bf16 v132, v90, v90, v132
  v_dot2_f32_bf16 v131, v91, v128, v131
  v_dot2_f32_bf16 v133, v91, v91, v133
  v_dot2_f32_bf16 v130, v92, v128, v130
  v_dot2_f32_bf16 v132, v92, v92, v132
  v_dot2_f32_bf16 v131, v93, v128, v131
  v_dot2_f32_bf16 v133, v93, v93, v133
  v_dot2_f32_bf16 v130, v94, v128, v130
  v_dot2_f32_bf16 v132, v94, v94, v132
  v_dot2_f32_bf16 v131, v95, v128, v131
  v_dot2_f32_bf16 v133, v95, v95, v133
  v_lshlrev_b32 v144, 16, v80
  v_and_b32 v145, 0xffff0000, v80
  v_lshlrev_b32 v146, 16, v81
  v_and_b32 v147, 0xffff0000, v81
  v_lshlrev_b32 v148, 16, v82
  v_and_b32 v149, 0xffff0000, v82
  v_lshlrev_b32 v150, 16, v83
  v_and_b32 v151, 0xffff0000, v83
  v_lshlrev_b32 v152, 16, v84
  v_and_b32 v153, 0xffff0000, v84
  v_lshlrev_b32 v154, 16, v85
  v_and_b32 v155, 0xffff0000, v85
  v_lshlrev_b32 v156, 16, v86
  v_and_b32 v157, 0xffff0000, v86
  v_lshlrev_b32 v158, 16, v87
  v_and_b32 v159, 0xffff0000, v87
  v_add_f32 v130, v130, v131
  v_add_f32 v132, v132, v133
  s_nop 0
  v_add_f32_dpp v130, v130, v130 quad_perm:[1,0,3,2] row_mask:0xf bank_mask:0xf
  v_add_f32_dpp v132, v132, v132 quad_perm:[1,0,3,2] row_mask:0xf bank_mask:0xf
  s_nop 0
  v_add_f32_dpp v130, v130, v130 quad_perm:[2,3,0,1] row_mask:0xf bank_mask:0xf
  v_add_f32_dpp v132, v132, v132 quad_perm:[2,3,0,1] row_mask:0xf bank_mask:0xf
  s_nop 0
  v_add_f32_dpp v130, v130, v130 row_half_mirror row_mask:0xf bank_mask:0xf
  v_add_f32_dpp v132, v132, v132 row_half_mirror row_mask:0xf bank_mask:0xf
  s_nop 0
  v_add_f32_dpp v130, v130, v130 row_mirror row_mask:0xf bank_mask:0xf
  v_add_f32_dpp v132, v132, v132 row_mirror row_mask:0xf bank_mask:0xf
  v_mul_f32 v130, 0x3b000000, v130
  v_mul_f32 v132, 0x3b000000, v132
  v_fma_f32 v132, -v130, v130, v132
  v_max_f32 v132, 0, v132
  v_add_f32 v133, 0x3727c5ac, v132
  v_rsq_f32 v137, v133
  v_mov_b32 v139, 0
  v_mul_f32 v136, v130, v137
  v_sub_f32 v136, 0, v136
  v_mul_f32 v138, v137, v137
  v_mul_f32 v138, v138, v132
  v_add_f32 v138, 0x3727c5ac, v138
  v_rsq_f32 v138, v138
  v_pk_fma_f32 v[144:145], v[144:145], v[136:137], v[136:137] op_sel:[0,1,0] op_sel_hi:[1,1,0]
  v_pk_fma_f32 v[146:147], v[146:147], v[136:137], v[136:137] op_sel:[0,1,0] op_sel_hi:[1,1,0]
  v_pk_fma_f32 v[148:149], v[148:149], v[136:137], v[136:137] op_sel:[0,1,0] op_sel_hi:[1,1,0]
  v_pk_fma_f32 v[150:151], v[150:151], v[136:137], v[136:137] op_sel:[0,1,0] op_sel_hi:[1,1,0]
  v_cvt_pk_bf16_f32 v80, v144, v145
  v_cvt_pk_bf16_f32 v81, v146, v147
  v_cvt_pk_bf16_f32 v82, v148, v149
  v_cvt_pk_bf16_f32 v83, v150, v151
  ds_write_b128 v62, v[80:83] offset:0
  v_pk_fma_f32 v[152:153], v[152:153], v[136:137], v[136:137] op_sel:[0,1,0] op_sel_hi:[1,1,0]
  v_pk_fma_f32 v[154:155], v[154:155], v[136:137], v[136:137] op_sel:[0,1,0] op_sel_hi:[1,1,0]
  v_pk_fma_f32 v[156:157], v[156:157], v[136:137], v[136:137] op_sel:[0,1,0] op_sel_hi:[1,1,0]
  v_pk_fma_f32 v[158:159], v[158:159], v[136:137], v[136:137] op_sel:[0,1,0] op_sel_hi:[1,1,0]
  v_cvt_pk_bf16_f32 v84, v152, v153
  v_cvt_pk_bf16_f32 v85, v154, v155
  v_cvt_pk_bf16_f32 v86, v156, v157
  v_cvt_pk_bf16_f32 v87, v158, v159
  ds_write_b128 v62, v[84:87] offset:16384
  v_lshlrev_b32 v144, 16, v88
  v_and_b32 v145, 0xffff0000, v88
  v_lshlrev_b32 v146, 16, v89
  v_and_b32 v147, 0xffff0000, v89
  v_lshlrev_b32 v148, 16, v90
  v_and_b32 v149, 0xffff0000, v90
  v_lshlrev_b32 v150, 16, v91
  v_and_b32 v151, 0xffff0000, v91
  v_pk_fma_f32 v[144:145], v[144:145], v[136:137], v[136:137] op_sel:[0,1,0] op_sel_hi:[1,1,0]
  v_pk_fma_f32 v[146:147], v[146:147], v[136:137], v[136:137] op_sel:[0,1,0] op_sel_hi:[1,1,0]
  v_pk_fma_f32 v[148:149], v[148:149], v[136:137], v[136:137] op_sel:[0,1,0] op_sel_hi:[1,1,0]
  v_pk_fma_f32 v[150:151], v[150:151], v[136:137], v[136:137] op_sel:[0,1,0] op_sel_hi:[1,1,0]
  v_cvt_pk_bf16_f32 v88, v144, v145
  v_cvt_pk_bf16_f32 v89, v146, v147
  v_cvt_pk_bf16_f32 v90, v148, v149
  v_cvt_pk_bf16_f32 v91, v150, v151
  ds_write_b128 v62, v[88:91] offset:32768
  v_lshlrev_b32 v152, 16, v92
  v_and_b32 v153, 0xffff0000, v92
  v_lshlrev_b32 v154, 16, v93
  v_and_b32 v155, 0xffff0000, v93
  v_lshlrev_b32 v156, 16, v94
  v_and_b32 v157, 0xffff0000, v94
  v_lshlrev_b32 v158, 16, v95
  v_and_b32 v159, 0xffff0000, v95
  v_pk_fma_f32 v[152:153], v[152:153], v[136:137], v[136:137] op_sel:[0,1,0] op_sel_hi:[1,1,0]
  v_pk_fma_f32 v[154:155], v[154:155], v[136:137], v[136:137] op_sel:[0,1,0] op_sel_hi:[1,1,0]
  v_pk_fma_f32 v[156:157], v[156:157], v[136:137], v[136:137] op_sel:[0,1,0] op_sel_hi:[1,1,0]
  v_pk_fma_f32 v[158:159], v[158:159], v[136:137], v[136:137] op_sel:[0,1,0] op_sel_hi:[1,1,0]
  v_cvt_pk_bf16_f32 v92, v152, v153
  v_cvt_pk_bf16_f32 v93, v154, v155
  v_cvt_pk_bf16_f32 v94, v156, v157
  v_cvt_pk_bf16_f32 v95, v158, v159
  ds_write_b128 v62, v[92:95] offset:49152
  ds_write_b128 v58, v[136:139] offset:64
  s_branch A_MAIN
B_PRE:
  s_sub_u32 s77, s26, 4
  v_lshrrev_b32 v22, 3, v0
  v_and_b32 v23, 7, v0
  v_bfe_u32 v24, v0, 4, 1
  v_lshlrev_b32 v24, 2, v24
  v_xor_b32 v23, v23, v24
  v_lshlrev_b32 v23, 4, v23
  v_mul_u32_u24 v8, 1024, v22
  v_add_u32 v8, v8, v23
  v_add_u32 v9, 7168, v8
  v_add_u32 v10, 14336, v8
  v_add_u32 v11, 21504, v8
  v_mul_u32_u24 v4, 3072, v22
  v_add_u32 v4, v4, v23
  v_add_u32 v5, 23552, v4
  v_add_u32 v6, 47104, v4
  v_add_u32 v7, 70656, v4
  v_mul_u32_u24 v12, 3584, v22
  v_add_u32 v12, v12, v23
  v_add_u32 v13, 27648, v12
  v_add_u32 v14, 55296, v12
  v_add_u32 v15, 82944, v12
  s_waitcnt lgkmcnt(0)
  s_mov_b32 s32, s4
  s_mov_b32 s33, s5
  s_mov_b32 s34, 0x200000
  s_mov_b32 s35, 0x00020000
  buffer_load_dwordx4 v[64:67], v60, s[32:35], 0 offen offset:0
  buffer_load_dwordx4 v[68:71], v60, s[32:35], 0 offen offset:256
  buffer_load_dwordx4 v[72:75], v60, s[32:35], 0 offen offset:512
  buffer_load_dwordx4 v[76:79], v60, s[32:35], 0 offen offset:768
  buffer_load_dwordx4 v[80:83], v60, s[32:35], s71 offen offset:0
  buffer_load_dwordx4 v[84:87], v60, s[32:35], s71 offen offset:256
  buffer_load_dwordx4 v[88:91], v60, s[32:35], s71 offen offset:512
  buffer_load_dwordx4 v[92:95], v60, s[32:35], s71 offen offset:768
  s_mov_b32 s40, s12
  s_mov_b32 s41, s13
  s_mov_b32 s42, 0x80000
  s_mov_b32 s43, 0x00020000
  s_mov_b32 s36, s6
  s_mov_b32 s37, s7
  s_mov_b32 s38, 0x180000
  s_mov_b32 s39, 0x00020000
  s_mov_b32 s60, s24
  s_mov_b32 s61, s25
  s_mov_b32 s62, 0x2800000
  s_mov_b32 s63, 0x00020000
  s_mov_b32 s48, s16
  s_mov_b32 s49, s17
  s_mov_b32 s50, 0x1c0000
  s_mov_b32 s51, 0x00020000
  s_mov_b32 s68, s22
  s_mov_b32 s69, s23
  s_mov_b32 s70, 0x100
  s_mov_b32 s71, 0x00020000
  s_mov_b32 s44, s14
  s_mov_b32 s45, s15
  s_mov_b32 s46, 0x80000
  s_mov_b32 s47, 0x00020000
  s_mov_b32 s52, s18
  s_mov_b32 s53, s19
  s_mov_b32 s54, 0x1c0000
  s_mov_b32 s55, 0x00020000
  s_mov_b32 s56, s8
  s_mov_b32 s57, s9
  s_mov_b32 s58, 0x80000
  s_mov_b32 s59, 0x00020000
  s_lshl_b32 s72, s85, 2
  s_add_u32 s72, s72, s77
  s_mul_i32 s72, s72, 16
  v_mov_b32 v28, v0
  v_add_u32 v28, s72, v28
  v_lshrrev_b32 v30, 2, v28
  v_and_b32 v28, 3, v28
  v_lshlrev_b32 v28, 7, v28
  s_movk_i32 s73, 1024
  v_mad_u32_u24 v28, v30, s73, v28
  s_and_b32 s73, s84, 1
  s_mul_i32 s73, s73, 512
  v_mov_b32 v30, 0x7f000000
  v_cmp_gt_u32 vcc, 16, v0
  s_nop 1
  v_cndmask_b32 v28, v30, v28, vcc
  buffer_load_dword v254, v28, s[40:43], s73 offen
  s_mov_b32 s18, s77
  s_lshl_b32 s4, s18, 13
  s_lshl_b32 s72, s28, 7
  s_cmp_eq_u32 s28, 3
  s_cselect_b32 s3, 512, 0
  s_cmp_eq_u32 s28, 7
  s_cselect_b32 s3, -512, s3
  s_lshl_b32 s73, s18, 16
  s_add_u32 s6, s73, s72
  s_mul_i32 s73, s18, 196608
  s_add_u32 s5, s73, s72
  s_add_u32 s5, s5, s3
  s_lshr_b32 s72, s27, 2
  s_lshl_b32 s72, s72, 2
  s_add_u32 s20, s72, s18
  s_and_b32 s74, s27, 3
  s_lshl_b32 s75, s28, 2
  s_add_u32 s22, s74, s75
  s_cmp_lt_u32 s27, 16
  s_cselect_b32 s75, 1, 0
  s_cmp_lt_u32 s28, 7
  s_cselect_b32 s75, s75, 0
  s_cmp_eq_u32 s75, 1
  s_cselect_b32 s21, 0, 0x7f000000
  v_lshlrev_b32 v16, 4, v0
  v_lshlrev_b32 v21, 2, v0
  s_lshl_b32 s72, s18, 12
  s_add_u32 s72, s72, 131072
  v_add_u32 v17, s72, v16
  v_mov_b32 v20, 0x7f000000
  v_mov_b32 v24, 0
  v_cmp_eq_u32 vcc, 0, v0
  s_nop 1
  v_cndmask_b32 v20, v20, v24, vcc
  s_lshl_b32 s72, s28, 9
  s_mul_i32 s73, s18, 229376
  s_add_u32 s7, s73, s72
  s_lshl_b32 s72, s31, 14
  s_lshl_b32 s73, s30, 12
  s_add_u32 s8, s72, s73
  s_lshl_b32 s72, s28, 7
  s_lshl_b32 s73, s18, 15
  s_add_u32 s9, s73, s72
  s_lshl_b32 s73, s30, 15
  s_add_u32 s72, s72, s73
  s_lshl_b32 s73, s31, 18
  s_add_u32 s10, s72, s73
  s_mul_i32 s73, s31, -1507328
  s_add_u32 s11, s72, s73
  s_lshl_b32 s19, s27, 1
  s_add_u32 s19, s19, s30
  s_mul_i32 s72, s19, 114688
  s_add_u32 s72, s72, 0xa00000
  s_lshl_b32 s73, s31, 14
  s_add_u32 s12, s72, s73
  s_mul_i32 s73, s31, -94208
  s_add_u32 s13, s72, s73
  s_lshl_b32 s73, s28, 14
  s_add_u32 s72, s72, s73
  s_lshl_b32 s73, s31, 11
  s_add_u32 s17, s72, s73
  s_lshl_b32 s72, s19, 15
  s_lshl_b32 s73, s31, 12
  s_add_u32 s24, s73, 0x200000
  s_add_u32 s73, s73, s72
  s_add_u32 s14, s73, 0x600000
  s_lshl_b32 s73, s31, 13
  s_add_u32 s73, s73, s72
  s_add_u32 s15, s73, 0x400000
  s_lshl_b32 s73, s28, 12
  s_add_u32 s72, s72, s73
  s_lshl_b32 s73, s31, 11
  s_add_u32 s72, s72, s73
  s_add_u32 s16, s72, 0x200000
  s_lshl_b32 s23, s27, 5
  s_lshl_b32 s72, s28, 2
  s_add_u32 s23, s23, s72
  s_add_u32 s23, s23, s18
  s_lshl_b32 s23, s23, 2
  s_waitcnt vmcnt(5)
  v_dot2_f32_bf16 v130, v64, v128, 0
  v_dot2_f32_bf16 v132, v64, v64, 0
  v_dot2_f32_bf16 v131, v65, v128, 0
  v_dot2_f32_bf16 v133, v65, v65, 0
  v_dot2_f32_bf16 v130, v66, v128, v130
  v_dot2_f32_bf16 v132, v66, v66, v132
  v_dot2_f32_bf16 v131, v67, v128, v131
  v_dot2_f32_bf16 v133, v67, v67, v133
  v_dot2_f32_bf16 v130, v68, v128, v130
  v_dot2_f32_bf16 v132, v68, v68, v132
  v_dot2_f32_bf16 v131, v69, v128, v131
  v_dot2_f32_bf16 v133, v69, v69, v133
  v_dot2_f32_bf16 v130, v70, v128, v130
  v_dot2_f32_bf16 v132, v70, v70, v132
  v_dot2_f32_bf16 v131, v71, v128, v131
  v_dot2_f32_bf16 v133, v71, v71, v133
  v_dot2_f32_bf16 v130, v72, v128, v130
  v_dot2_f32_bf16 v132, v72, v72, v132
  v_dot2_f32_bf16 v131, v73, v128, v131
  v_dot2_f32_bf16 v133, v73, v73, v133
  v_dot2_f32_bf16 v130, v74, v128, v130
  v_dot2_f32_bf16 v132, v74, v74, v132
  v_dot2_f32_bf16 v131, v75, v128, v131
  v_dot2_f32_bf16 v133, v75, v75, v133
  v_dot2_f32_bf16 v130, v76, v128, v130
  v_dot2_f32_bf16 v132, v76, v76, v132
  v_dot2_f32_bf16 v131, v77, v128, v131
  v_dot2_f32_bf16 v133, v77, v77, v133
  v_dot2_f32_bf16 v130, v78, v128, v130
  v_dot2_f32_bf16 v132, v78, v78, v132
  v_dot2_f32_bf16 v131, v79, v128, v131
  v_dot2_f32_bf16 v133, v79, v79, v133
  v_lshlrev_b32 v144, 16, v64
  v_and_b32 v145, 0xffff0000, v64
  v_lshlrev_b32 v146, 16, v65
  v_and_b32 v147, 0xffff0000, v65
  v_lshlrev_b32 v148, 16, v66
  v_and_b32 v149, 0xffff0000, v66
  v_lshlrev_b32 v150, 16, v67
  v_and_b32 v151, 0xffff0000, v67
  v_lshlrev_b32 v152, 16, v68
  v_and_b32 v153, 0xffff0000, v68
  v_lshlrev_b32 v154, 16, v69
  v_and_b32 v155, 0xffff0000, v69
  v_lshlrev_b32 v156, 16, v70
  v_and_b32 v157, 0xffff0000, v70
  v_lshlrev_b32 v158, 16, v71
  v_and_b32 v159, 0xffff0000, v71
  v_add_f32 v130, v130, v131
  v_add_f32 v132, v132, v133
  s_nop 0
  v_add_f32_dpp v130, v130, v130 quad_perm:[1,0,3,2] row_mask:0xf bank_mask:0xf
  v_add_f32_dpp v132, v132, v132 quad_perm:[1,0,3,2] row_mask:0xf bank_mask:0xf
  s_nop 0
  v_add_f32_dpp v130, v130, v130 quad_perm:[2,3,0,1] row_mask:0xf bank_mask:0xf
  v_add_f32_dpp v132, v132, v132 quad_perm:[2,3,0,1] row_mask:0xf bank_mask:0xf
  s_nop 0
  v_add_f32_dpp v130, v130, v130 row_half_mirror row_mask:0xf bank_mask:0xf
  v_add_f32_dpp v132, v132, v132 row_half_mirror row_mask:0xf bank_mask:0xf
  s_nop 0
  v_add_f32_dpp v130, v130, v130 row_mirror row_mask:0xf bank_mask:0xf
  v_add_f32_dpp v132, v132, v132 row_mirror row_mask:0xf bank_mask:0xf
  v_mul_f32 v130, 0x3b000000, v130
  v_mul_f32 v132, 0x3b000000, v132
  v_fma_f32 v132, -v130, v130, v132
  v_max_f32 v132, 0, v132
  v_add_f32 v133, 0x3727c5ac, v132
  v_rsq_f32 v137, v133
  v_mov_b32 v139, 0
  v_mul_f32 v136, v130, v137
  v_sub_f32 v136, 0, v136
  v_mul_f32 v138, v137, v137
  v_mul_f32 v138, v138, v132
  v_add_f32 v138, 0x3727c5ac, v138
  v_rsq_f32 v138, v138
  v_pk_fma_f32 v[144:145], v[144:145], v[136:137], v[136:137] op_sel:[0,1,0] op_sel_hi:[1,1,0]
  v_pk_fma_f32 v[146:147], v[146:147], v[136:137], v[136:137] op_sel:[0,1,0] op_sel_hi:[1,1,0]
  v_pk_fma_f32 v[148:149], v[148:149], v[136:137], v[136:137] op_sel:[0,1,0] op_sel_hi:[1,1,0]
  v_pk_fma_f32 v[150:151], v[150:151], v[136:137], v[136:137] op_sel:[0,1,0] op_sel_hi:[1,1,0]
  v_cvt_pk_bf16_f32 v64, v144, v145
  v_cvt_pk_bf16_f32 v65, v146, v147
  v_cvt_pk_bf16_f32 v66, v148, v149
  v_cvt_pk_bf16_f32 v67, v150, v151
  ds_write_b128 v61, v[64:67] offset:0
  v_pk_fma_f32 v[152:153], v[152:153], v[136:137], v[136:137] op_sel:[0,1,0] op_sel_hi:[1,1,0]
  v_pk_fma_f32 v[154:155], v[154:155], v[136:137], v[136:137] op_sel:[0,1,0] op_sel_hi:[1,1,0]
  v_pk_fma_f32 v[156:157], v[156:157], v[136:137], v[136:137] op_sel:[0,1,0] op_sel_hi:[1,1,0]
  v_pk_fma_f32 v[158:159], v[158:159], v[136:137], v[136:137] op_sel:[0,1,0] op_sel_hi:[1,1,0]
  v_cvt_pk_bf16_f32 v68, v152, v153
  v_cvt_pk_bf16_f32 v69, v154, v155
  v_cvt_pk_bf16_f32 v70, v156, v157
  v_cvt_pk_bf16_f32 v71, v158, v159
  ds_write_b128 v61, v[68:71] offset:16384
  v_lshlrev_b32 v144, 16, v72
  v_and_b32 v145, 0xffff0000, v72
  v_lshlrev_b32 v146, 16, v73
  v_and_b32 v147, 0xffff0000, v73
  v_lshlrev_b32 v148, 16, v74
  v_and_b32 v149, 0xffff0000, v74
  v_lshlrev_b32 v150, 16, v75
  v_and_b32 v151, 0xffff0000, v75
  v_pk_fma_f32 v[144:145], v[144:145], v[136:137], v[136:137] op_sel:[0,1,0] op_sel_hi:[1,1,0]
  v_pk_fma_f32 v[146:147], v[146:147], v[136:137], v[136:137] op_sel:[0,1,0] op_sel_hi:[1,1,0]
  v_pk_fma_f32 v[148:149], v[148:149], v[136:137], v[136:137] op_sel:[0,1,0] op_sel_hi:[1,1,0]
  v_pk_fma_f32 v[150:151], v[150:151], v[136:137], v[136:137] op_sel:[0,1,0] op_sel_hi:[1,1,0]
  v_cvt_pk_bf16_f32 v72, v144, v145
  v_cvt_pk_bf16_f32 v73, v146, v147
  v_cvt_pk_bf16_f32 v74, v148, v149
  v_cvt_pk_bf16_f32 v75, v150, v151
  ds_write_b128 v61, v[72:75] offset:32768
  v_lshlrev_b32 v152, 16, v76
  v_and_b32 v153, 0xffff0000, v76
  v_lshlrev_b32 v154, 16, v77
  v_and_b32 v155, 0xffff0000, v77
  v_lshlrev_b32 v156, 16, v78
  v_and_b32 v157, 0xffff0000, v78
  v_lshlrev_b32 v158, 16, v79
  v_and_b32 v159, 0xffff0000, v79
  v_pk_fma_f32 v[152:153], v[152:153], v[136:137], v[136:137] op_sel:[0,1,0] op_sel_hi:[1,1,0]
  v_pk_fma_f32 v[154:155], v[154:155], v[136:137], v[136:137] op_sel:[0,1,0] op_sel_hi:[1,1,0]
  v_pk_fma_f32 v[156:157], v[156:157], v[136:137], v[136:137] op_sel:[0,1,0] op_sel_hi:[1,1,0]
  v_pk_fma_f32 v[158:159], v[158:159], v[136:137], v[136:137] op_sel:[0,1,0] op_sel_hi:[1,1,0]
  v_cvt_pk_bf16_f32 v76, v152, v153
  v_cvt_pk_bf16_f32 v77, v154, v155
  v_cvt_pk_bf16_f32 v78, v156, v157
  v_cvt_pk_bf16_f32 v79, v158, v159
  ds_write_b128 v61, v[76:79] offset:49152
  ds_write_b128 v58, v[136:139] offset:0
  s_add_u32 m0, s4, 65536
  s_add_u32 s72, s6, 0x0
  buffer_load_dwordx4 v8, s[40:43], s72 offen offset:0 lds
  buffer_load_dwordx4 v9, s[40:43], s72 offen offset:1024 lds
  buffer_load_dwordx4 v10, s[40:43], s72 offen offset:2048 lds
  buffer_load_dwordx4 v11, s[40:43], s72 offen offset:3072 lds
  s_add_u32 m0, s4, 69632
  s_add_u32 s72, s6, 0x8000
  buffer_load_dwordx4 v8, s[40:43], s72 offen offset:0 lds
  buffer_load_dwordx4 v9, s[40:43], s72 offen offset:1024 lds
  buffer_load_dwordx4 v10, s[40:43], s72 offen offset:2048 lds
  buffer_load_dwordx4 v11, s[40:43], s72 offen offset:3072 lds
  s_lshl_b32 s72, s85, 2
  s_add_u32 s72, s72, s77
  s_mul_i32 s72, s72, 16
  v_lshrrev_b32 v29, 4, v0
  v_and_b32 v28, 15, v0
  v_add_u32 v28, s72, v28
  v_lshrrev_b32 v30, 2, v28
  v_and_b32 v28, 3, v28
  s_and_b32 s73, s84, 1
  s_lshl_b32 s73, s73, 3
  s_sub_u32 s73, 4, s73
  v_add_u32 v31, s73, v28
  v_cmp_eq_u32 vcc, 3, v28
  s_nop 1
  v_cndmask_b32 v28, v28, v31, vcc
  v_lshlrev_b32 v28, 7, v28
  s_movk_i32 s73, 3072
  v_mad_u32_u24 v28, v30, s73, v28
  s_movk_i32 s73, 1024
  v_mad_u32_u24 v28, v29, s73, v28
  s_and_b32 s73, s84, 1
  s_mul_i32 s73, s73, 512
  s_add_u32 s73, s73, 1024
  v_mov_b32 v30, 0x7f000000
  v_cmp_gt_u32 vcc, 32, v0
  s_nop 1
  v_cndmask_b32 v28, v30, v28, vcc
  buffer_load_dword v254, v28, s[36:39], s73 offen
  s_waitcnt vmcnt(10)
  v_dot2_f32_bf16 v130, v80, v128, 0
  v_dot2_f32_bf16 v132, v80, v80, 0
  v_dot2_f32_bf16 v131, v81, v128, 0
  v_dot2_f32_bf16 v133, v81, v81, 0
  v_dot2_f32_bf16 v130, v82, v128, v130
  v_dot2_f32_bf16 v132, v82, v82, v132
  v_dot2_f32_bf16 v131, v83, v128, v131
  v_dot2_f32_bf16 v133, v83, v83, v133
  v_dot2_f32_bf16 v130, v84, v128, v130
  v_dot2_f32_bf16 v132, v84, v84, v132
  v_dot2_f32_bf16 v131, v85, v128, v131
  v_dot2_f32_bf16 v133, v85, v85, v133
  v_dot2_f32_bf16 v130, v86, v128, v130
  v_dot2_f32_bf16 v132, v86, v86, v132
  v_dot2_f32_bf16 v131, v87, v128, v131
  v_dot2_f32_bf16 v133, v87, v87, v133
  v_dot2_f32_bf16 v130, v88, v128, v130
  v_dot2_f32_bf16 v132, v88, v88, v132
  v_dot2_f32_bf16 v131, v89, v128, v131
  v_dot2_f32_bf16 v133, v89, v89, v133
  v_dot2_f32_bf16 v130, v90, v128, v130
  v_dot2_f32_bf16 v132, v90, v90, v132
  v_dot2_f32_bf16 v131, v91, v128, v131
  v_dot2_f32_bf16 v133, v91, v91, v133
  v_dot2_f32_bf16 v130, v92, v128, v130
  v_dot2_f32_bf16 v132, v92, v92, v132
  v_dot2_f32_bf16 v131, v93, v128, v131
  v_dot2_f32_bf16 v133, v93, v93, v133
  v_dot2_f32_bf16 v130, v94, v128, v130
  v_dot2_f32_bf16 v132, v94, v94, v132
  v_dot2_f32_bf16 v131, v95, v128, v131
  v_dot2_f32_bf16 v133, v95, v95, v133
  v_lshlrev_b32 v144, 16, v80
  v_and_b32 v145, 0xffff0000, v80
  v_lshlrev_b32 v146, 16, v81
  v_and_b32 v147, 0xffff0000, v81
  v_lshlrev_b32 v148, 16, v82
  v_and_b32 v149, 0xffff0000, v82
  v_lshlrev_b32 v150, 16, v83
  v_and_b32 v151, 0xffff0000, v83
  v_lshlrev_b32 v152, 16, v84
  v_and_b32 v153, 0xffff0000, v84
  v_lshlrev_b32 v154, 16, v85
  v_and_b32 v155, 0xffff0000, v85
  v_lshlrev_b32 v156, 16, v86
  v_and_b32 v157, 0xffff0000, v86
  v_lshlrev_b32 v158, 16, v87
  v_and_b32 v159, 0xffff0000, v87
  v_add_f32 v130, v130, v131
  v_add_f32 v132, v132, v133
  s_nop 0
  v_add_f32_dpp v130, v130, v130 quad_perm:[1,0,3,2] row_mask:0xf bank_mask:0xf
  v_add_f32_dpp v132, v132, v132 quad_perm:[1,0,3,2] row_mask:0xf bank_mask:0xf
  s_nop 0
  v_add_f32_dpp v130, v130, v130 quad_perm:[2,3,0,1] row_mask:0xf bank_mask:0xf
  v_add_f32_dpp v132, v132, v132 quad_perm:[2,3,0,1] row_mask:0xf bank_mask:0xf
  s_nop 0
  v_add_f32_dpp v130, v130, v130 row_half_mirror row_mask:0xf bank_mask:0xf
  v_add_f32_dpp v132, v132, v132 row_half_mirror row_mask:0xf bank_mask:0xf
  s_nop 0
  v_add_f32_dpp v130, v130, v130 row_mirror row_mask:0xf bank_mask:0xf
  v_add_f32_dpp v132, v132, v132 row_mirror row_mask:0xf bank_mask:0xf
  v_mul_f32 v130, 0x3b000000, v130
  v_mul_f32 v132, 0x3b000000, v132
  v_fma_f32 v132, -v130, v130, v132
  v_max_f32 v132, 0, v132
  v_add_f32 v133, 0x3727c5ac, v132
  v_rsq_f32 v137, v133
  v_mov_b32 v139, 0
  v_mul_f32 v136, v130, v137
  v_sub_f32 v136, 0, v136
  v_mul_f32 v138, v137, v137
  v_mul_f32 v138, v138, v132
  v_add_f32 v138, 0x3727c5ac, v138
  v_rsq_f32 v138, v138
  v_pk_fma_f32 v[144:145], v[144:145], v[136:137], v[136:137] op_sel:[0,1,0] op_sel_hi:[1,1,0]
  v_pk_fma_f32 v[146:147], v[146:147], v[136:137], v[136:137] op_sel:[0,1,0] op_sel_hi:[1,1,0]
  v_pk_fma_f32 v[148:149], v[148:149], v[136:137], v[136:137] op_sel:[0,1,0] op_sel_hi:[1,1,0]
  v_pk_fma_f32 v[150:151], v[150:151], v[136:137], v[136:137] op_sel:[0,1,0] op_sel_hi:[1,1,0]
  v_cvt_pk_bf16_f32 v80, v144, v145
  v_cvt_pk_bf16_f32 v81, v146, v147
  v_cvt_pk_bf16_f32 v82, v148, v149
  v_cvt_pk_bf16_f32 v83, v150, v151
  ds_write_b128 v62, v[80:83] offset:0
  v_pk_fma_f32 v[152:153], v[152:153], v[136:137], v[136:137] op_sel:[0,1,0] op_sel_hi:[1,1,0]
  v_pk_fma_f32 v[154:155], v[154:155], v[136:137], v[136:137] op_sel:[0,1,0] op_sel_hi:[1,1,0]
  v_pk_fma_f32 v[156:157], v[156:157], v[136:137], v[136:137] op_sel:[0,1,0] op_sel_hi:[1,1,0]
  v_pk_fma_f32 v[158:159], v[158:159], v[136:137], v[136:137] op_sel:[0,1,0] op_sel_hi:[1,1,0]
  v_cvt_pk_bf16_f32 v84, v152, v153
  v_cvt_pk_bf16_f32 v85, v154, v155
  v_cvt_pk_bf16_f32 v86, v156, v157
  v_cvt_pk_bf16_f32 v87, v158, v159
  ds_write_b128 v62, v[84:87] offset:16384
  v_lshlrev_b32 v144, 16, v88
  v_and_b32 v145, 0xffff0000, v88
  v_lshlrev_b32 v146, 16, v89
  v_and_b32 v147, 0xffff0000, v89
  v_lshlrev_b32 v148, 16, v90
  v_and_b32 v149, 0xffff0000, v90
  v_lshlrev_b32 v150, 16, v91
  v_and_b32 v151, 0xffff0000, v91
  v_pk_fma_f32 v[144:145], v[144:145], v[136:137], v[136:137] op_sel:[0,1,0] op_sel_hi:[1,1,0]
  v_pk_fma_f32 v[146:147], v[146:147], v[136:137], v[136:137] op_sel:[0,1,0] op_sel_hi:[1,1,0]
  v_pk_fma_f32 v[148:149], v[148:149], v[136:137], v[136:137] op_sel:[0,1,0] op_sel_hi:[1,1,0]
  v_pk_fma_f32 v[150:151], v[150:151], v[136:137], v[136:137] op_sel:[0,1,0] op_sel_hi:[1,1,0]
  v_cvt_pk_bf16_f32 v88, v144, v145
  v_cvt_pk_bf16_f32 v89, v146, v147
  v_cvt_pk_bf16_f32 v90, v148, v149
  v_cvt_pk_bf16_f32 v91, v150, v151
  ds_write_b128 v62, v[88:91] offset:32768
  v_lshlrev_b32 v152, 16, v92
  v_and_b32 v153, 0xffff0000, v92
  v_lshlrev_b32 v154, 16, v93
  v_and_b32 v155, 0xffff0000, v93
  v_lshlrev_b32 v156, 16, v94
  v_and_b32 v157, 0xffff0000, v94
  v_lshlrev_b32 v158, 16, v95
  v_and_b32 v159, 0xffff0000, v95
  v_pk_fma_f32 v[152:153], v[152:153], v[136:137], v[136:137] op_sel:[0,1,0] op_sel_hi:[1,1,0]
  v_pk_fma_f32 v[154:155], v[154:155], v[136:137], v[136:137] op_sel:[0,1,0] op_sel_hi:[1,1,0]
  v_pk_fma_f32 v[156:157], v[156:157], v[136:137], v[136:137] op_sel:[0,1,0] op_sel_hi:[1,1,0]
  v_pk_fma_f32 v[158:159], v[158:159], v[136:137], v[136:137] op_sel:[0,1,0] op_sel_hi:[1,1,0]
  v_cvt_pk_bf16_f32 v92, v152, v153
  v_cvt_pk_bf16_f32 v93, v154, v155
  v_cvt_pk_bf16_f32 v94, v156, v157
  v_cvt_pk_bf16_f32 v95, v158, v159
  ds_write_b128 v62, v[92:95] offset:49152
  ds_write_b128 v58, v[136:139] offset:64
  s_add_u32 m0, s4, 98304
  s_add_u32 s72, s6, 0x40000
  buffer_load_dwordx4 v8, s[40:43], s72 offen offset:0 lds
  buffer_load_dwordx4 v9, s[40:43], s72 offen offset:1024 lds
  buffer_load_dwordx4 v10, s[40:43], s72 offen offset:2048 lds
  buffer_load_dwordx4 v11, s[40:43], s72 offen offset:3072 lds
  s_add_u32 m0, s4, 102400
  s_add_u32 s72, s6, 0x48000
  buffer_load_dwordx4 v8, s[40:43], s72 offen offset:0 lds
  buffer_load_dwordx4 v9, s[40:43], s72 offen offset:1024 lds
  buffer_load_dwordx4 v10, s[40:43], s72 offen offset:2048 lds
  buffer_load_dwordx4 v11, s[40:43], s72 offen offset:3072 lds
  buffer_load_dword v63, v59, s[68:71], 0 offen sc1
  s_branch B_MAIN
A_MAIN:
  s_waitcnt vmcnt(0) lgkmcnt(0)
  v_readfirstlane_b32 s29, v63
  s_cmp_lg_u32 s29, 0
  s_cbranch_scc1 ND_2
NC_1:
  v_mov_b32 v59, 0
  buffer_load_dword v63, v59, s[68:71], 0 offen sc1
  s_waitcnt vmcnt(0)
  v_readfirstlane_b32 s29, v63
  s_sub_u32 s78, s78, 1
  s_cmp_le_i32 s78, 0
  s_cbranch_scc1 ND_2
  s_cmp_eq_u32 s29, 0
  s_cbranch_scc1 NC_1
ND_2:
  v_mov_b32 v19, s29
  s_barrier
  ds_read_b64_tr_b16 v[96:97], v7 offset:0
  ds_read_b64_tr_b16 v[98:99], v7 offset:512
  ds_read_b128 v[128:131], v12 offset:0
  ds_read_b128 v[132:135], v13 offset:0
  ds_read_b128 v[136:139], v14 offset:0
  ds_read_b128 v[140:143], v15 offset:0
  ds_read_b64_tr_b16 v[100:101], v7 offset:2048
  ds_read_b64_tr_b16 v[102:103], v7 offset:2560
  ds_read_b128 v[144:147], v12 offset:8192
  ds_read_b128 v[148:151], v13 offset:8192
  ds_read_b128 v[152:155], v14 offset:8192
  ds_read_b128 v[156:159], v15 offset:8192
  ds_read_b64_tr_b16 v[104:105], v7 offset:4096
  ds_read_b64_tr_b16 v[106:107], v7 offset:4608
  ds_read_b128 v[160:163], v12 offset:16384
  s_waitcnt lgkmcnt(14)
  ds_read_b128 v[164:167], v13 offset:16384
  s_waitcnt lgkmcnt(14)
  ds_read_b128 v[168:171], v14 offset:16384
  s_waitcnt lgkmcnt(14)
  ds_read_b128 v[172:175], v15 offset:16384
  s_waitcnt lgkmcnt(14)
  ds_read_b64_tr_b16 v[108:109], v7 offset:6144
  s_waitcnt lgkmcnt(14)
  ds_read_b64_tr_b16 v[110:111], v7 offset:6656
  s_waitcnt lgkmcnt(14)
  ds_read_b128 v[176:179], v12 offset:24576
  s_waitcnt lgkmcnt(14)
  ds_read_b128 v[180:183], v13 offset:24576
  s_waitcnt lgkmcnt(14)
  ds_read_b128 v[184:187], v14 offset:24576
  s_waitcnt lgkmcnt(14)
  ds_read_b128 v[188:191], v15 offset:24576
  v_mfma_f32_32x32x16_bf16 v[32:47], v[96:99], v[128:131], 0
  s_waitcnt lgkmcnt(14)
  ds_read_b64_tr_b16 v[112:113], v7 offset:8192
  s_waitcnt lgkmcnt(14)
  ds_read_b64_tr_b16 v[114:115], v7 offset:8704
  s_waitcnt lgkmcnt(14)
  ds_read_b128 v[192:195], v12 offset:32768
  s_waitcnt lgkmcnt(14)
  ds_read_b128 v[196:199], v13 offset:32768
  s_waitcnt lgkmcnt(14)
  ds_read_b128 v[200:203], v14 offset:32768
  s_waitcnt lgkmcnt(14)
  ds_read_b128 v[204:207], v15 offset:32768
  v_mfma_f32_32x32x16_bf16 v[32:47], v[100:103], v[132:135], v[32:47]
  s_waitcnt lgkmcnt(14)
  ds_read_b64_tr_b16 v[116:117], v7 offset:10240
  s_waitcnt lgkmcnt(14)
  ds_read_b64_tr_b16 v[118:119], v7 offset:10752
  s_waitcnt lgkmcnt(14)
  ds_read_b128 v[208:211], v12 offset:40960
  s_waitcnt lgkmcnt(14)
  ds_read_b128 v[212:215], v13 offset:40960
  s_waitcnt lgkmcnt(14)
  ds_read_b128 v[216:219], v14 offset:40960
  s_waitcnt lgkmcnt(14)
  ds_read_b128 v[220:223], v15 offset:40960
  v_mfma_f32_32x32x16_bf16 v[32:47], v[104:107], v[136:139], v[32:47]
  s_waitcnt lgkmcnt(14)
  ds_read_b64_tr_b16 v[120:121], v7 offset:12288
  s_waitcnt lgkmcnt(14)
  ds_read_b64_tr_b16 v[122:123], v7 offset:12800
  s_waitcnt lgkmcnt(14)
  ds_read_b128 v[224:227], v12 offset:49152
  s_waitcnt lgkmcnt(14)
  ds_read_b128 v[228:231], v13 offset:49152
  s_waitcnt lgkmcnt(14)
  ds_read_b128 v[232:235], v14 offset:49152
  s_waitcnt lgkmcnt(14)
  ds_read_b128 v[236:239], v15 offset:49152
  v_mfma_f32_32x32x16_bf16 v[32:47], v[108:111], v[140:143], v[32:47]
  s_waitcnt lgkmcnt(14)
  ds_read_b64_tr_b16 v[124:125], v7 offset:14336
  s_waitcnt lgkmcnt(14)
  ds_read_b64_tr_b16 v[126:127], v7 offset:14848
  s_waitcnt lgkmcnt(14)
  ds_read_b128 v[240:243], v12 offset:57344
  s_waitcnt lgkmcnt(14)
  ds_read_b128 v[244:247], v13 offset:57344
  s_waitcnt lgkmcnt(14)
  ds_read_b128 v[248:251], v14 offset:57344
  s_waitcnt lgkmcnt(14)
  ds_read_b128 v[252:255], v15 offset:57344
  v_mfma_f32_32x32x16_bf16 v[32:47], v[112:115], v[144:147], v[32:47]
  s_waitcnt lgkmcnt(14)
  ds_read_b64_tr_b16 v[96:97], v7 offset:16384
  s_waitcnt lgkmcnt(14)
  ds_read_b64_tr_b16 v[98:99], v7 offset:16896
  v_mfma_f32_32x32x16_bf16 v[32:47], v[116:119], v[148:151], v[32:47]
  s_waitcnt lgkmcnt(2)
  s_barrier
  ds_read_b64_tr_b16 v[100:101], v7 offset:18432
  ds_read_b64_tr_b16 v[102:103], v7 offset:18944
  ds_read_b64_tr_b16 v[104:105], v7 offset:20480
  ds_read_b64_tr_b16 v[106:107], v7 offset:20992
  ds_read_b64_tr_b16 v[108:109], v7 offset:22528
  ds_read_b64_tr_b16 v[110:111], v7 offset:23040
  ds_read_b64_tr_b16 v[112:113], v7 offset:24576
  ds_read_b64_tr_b16 v[114:115], v7 offset:25088
  v_mfma_f32_32x32x16_bf16 v[32:47], v[120:123], v[152:155], v[32:47]
  ds_read_b64_tr_b16 v[116:117], v7 offset:26624
  ds_read_b64_tr_b16 v[118:119], v7 offset:27136
  v_mfma_f32_32x32x16_bf16 v[32:47], v[124:127], v[156:159], v[32:47]
  ds_read_b64_tr_b16 v[120:121], v7 offset:28672
  ds_read_b64_tr_b16 v[122:123], v7 offset:29184
  s_waitcnt lgkmcnt(12)
  v_mfma_f32_32x32x16_bf16 v[32:47], v[96:99], v[160:163], v[32:47]
  ds_read_b64_tr_b16 v[124:125], v7 offset:30720
  ds_read_b64_tr_b16 v[126:127], v7 offset:31232
  s_waitcnt lgkmcnt(10)
  v_mfma_f32_32x32x16_bf16 v[32:47], v[100:103], v[164:167], v[32:47]
  v_mfma_f32_32x32x16_bf16 v[32:47], v[104:107], v[168:171], v[32:47]
  s_waitcnt lgkmcnt(6)
  v_mfma_f32_32x32x16_bf16 v[32:47], v[108:111], v[172:175], v[32:47]
  v_mfma_f32_32x32x16_bf16 v[32:47], v[112:115], v[176:179], v[32:47]
  s_waitcnt lgkmcnt(0)
  s_barrier
  ds_read_b64_tr_b16 v[96:97], v7 offset:32768
  ds_read_b64_tr_b16 v[98:99], v7 offset:33280
  ds_read_b64_tr_b16 v[100:101], v7 offset:34816
  ds_read_b64_tr_b16 v[102:103], v7 offset:35328
  ds_read_b64_tr_b16 v[104:105], v7 offset:36864
  ds_read_b64_tr_b16 v[106:107], v7 offset:37376
  ds_read_b64_tr_b16 v[108:109], v7 offset:38912
  ds_read_b64_tr_b16 v[110:111], v7 offset:39424
  v_mfma_f32_32x32x16_bf16 v[32:47], v[116:119], v[180:183], v[32:47]
  ds_read_b64_tr_b16 v[112:113], v7 offset:40960
  ds_read_b64_tr_b16 v[114:115], v7 offset:41472
  v_mfma_f32_32x32x16_bf16 v[32:47], v[120:123], v[184:187], v[32:47]
  ds_read_b64_tr_b16 v[116:117], v7 offset:43008
  ds_read_b64_tr_b16 v[118:119], v7 offset:43520
  v_mfma_f32_32x32x16_bf16 v[32:47], v[124:127], v[188:191], v[32:47]
  ds_read_b64_tr_b16 v[120:121], v7 offset:45056
  ds_read_b64_tr_b16 v[122:123], v7 offset:45568
  s_waitcnt lgkmcnt(10)
  v_mfma_f32_32x32x16_bf16 v[32:47], v[96:99], v[192:195], v[32:47]
  ds_read_b64_tr_b16 v[124:125], v7 offset:47104
  ds_read_b64_tr_b16 v[126:127], v7 offset:47616
  v_mfma_f32_32x32x16_bf16 v[32:47], v[100:103], v[196:199], v[32:47]
  s_lshl_b32 s72, s30, 9
  s_add_u32 s72, s72, 155656
  v_lshl_add_u32 v31, v1, 4, s72
  ds_read_b32 v4, v31
  s_add_u32 s12, s7, 0x200000
  s_mov_b32 s13, 0x358637bd
  ds_read_b64_tr_b16 v[96:97], v7 offset:49152
  ds_read_b64_tr_b16 v[98:99], v7 offset:49664
  s_waitcnt lgkmcnt(11)
  v_mfma_f32_32x32x16_bf16 v[32:47], v[104:107], v[200:203], v[32:47]
  ds_read_b64_tr_b16 v[100:101], v7 offset:51200
  ds_read_b64_tr_b16 v[102:103], v7 offset:51712
  v_mfma_f32_32x32x16_bf16 v[32:47], v[108:111], v[204:207], v[32:47]
  ds_read_b64_tr_b16 v[104:105], v7 offset:53248
  ds_read_b64_tr_b16 v[106:107], v7 offset:53760
  s_waitcnt lgkmcnt(11)
  v_mfma_f32_32x32x16_bf16 v[32:47], v[112:115], v[208:211], v[32:47]
  ds_read_b64_tr_b16 v[108:109], v7 offset:55296
  ds_read_b64_tr_b16 v[110:111], v7 offset:55808
  v_mfma_f32_32x32x16_bf16 v[32:47], v[116:119], v[212:215], v[32:47]
  ds_read_b64_tr_b16 v[112:113], v7 offset:57344
  ds_read_b64_tr_b16 v[114:115], v7 offset:57856
  s_waitcnt lgkmcnt(11)
  v_mfma_f32_32x32x16_bf16 v[32:47], v[120:123], v[216:219], v[32:47]
  ds_read_b64_tr_b16 v[116:117], v7 offset:59392
  ds_read_b64_tr_b16 v[118:119], v7 offset:59904
  v_mfma_f32_32x32x16_bf16 v[32:47], v[124:127], v[220:223], v[32:47]
  ds_read_b64_tr_b16 v[120:121], v7 offset:61440
  ds_read_b64_tr_b16 v[122:123], v7 offset:61952
  s_waitcnt lgkmcnt(10)
  v_mfma_f32_32x32x16_bf16 v[32:47], v[96:99], v[224:227], v[32:47]
  v_mul_f32 v13, 0xc0135761, v4
  v_mul_f32 v14, v4, v4
  v_rcp_f32 v15, v4
  v_mul_f32 v14, v14, v4
  v_mul_f32 v14, 0xbdd2d3e8, v14
  ds_read_b64_tr_b16 v[124:125], v7 offset:63488
  ds_read_b64_tr_b16 v[126:127], v7 offset:64000
  v_mfma_f32_32x32x16_bf16 v[32:47], v[100:103], v[228:231], v[32:47]
  s_waitcnt lgkmcnt(8)
  v_mfma_f32_32x32x16_bf16 v[32:47], v[104:107], v[232:235], v[32:47]
  v_mfma_f32_32x32x16_bf16 v[32:47], v[108:111], v[236:239], v[32:47]
  s_waitcnt lgkmcnt(4)
  v_mfma_f32_32x32x16_bf16 v[32:47], v[112:115], v[240:243], v[32:47]
  s_waitcnt lgkmcnt(0)
  s_barrier
  ds_read_b64_tr_b16 v[96:97], v6 offset:0
  ds_read_b64_tr_b16 v[98:99], v6 offset:512
  ds_read_b64_tr_b16 v[100:101], v6 offset:2048
  ds_read_b64_tr_b16 v[102:103], v6 offset:2560
  ds_read_b64_tr_b16 v[104:105], v6 offset:4096
  ds_read_b64_tr_b16 v[106:107], v6 offset:4608
  ds_read_b64_tr_b16 v[108:109], v6 offset:6144
  ds_read_b64_tr_b16 v[110:111], v6 offset:6656
  v_mfma_f32_32x32x16_bf16 v[32:47], v[116:119], v[244:247], v[32:47]
  ds_read_b64_tr_b16 v[112:113], v6 offset:8192
  ds_read_b64_tr_b16 v[114:115], v6 offset:8704
  v_mfma_f32_32x32x16_bf16 v[32:47], v[120:123], v[248:251], v[32:47]
  ds_read_b64_tr_b16 v[116:117], v6 offset:10240
  ds_read_b64_tr_b16 v[118:119], v6 offset:10752
  v_mfma_f32_32x32x16_bf16 v[48:63], v[124:127], v[252:255], v[32:47]
  ds_read_b64_tr_b16 v[120:121], v6 offset:12288
  ds_read_b64_tr_b16 v[122:123], v6 offset:12800
  s_waitcnt lgkmcnt(10)
  s_nop 3
  v_mfma_f32_32x32x16_bf16 v[32:47], v[128:131], v[96:99], 0
  ds_read_b64_tr_b16 v[124:125], v6 offset:14336
  ds_read_b64_tr_b16 v[126:127], v6 offset:14848
  v_mfma_f32_32x32x16_bf16 v[32:47], v[132:135], v[100:103], v[32:47]
  ds_read_b64_tr_b16 v[96:97], v6 offset:16384
  ds_read_b64_tr_b16 v[98:99], v6 offset:16896
  s_waitcnt lgkmcnt(10)
  v_mfma_f32_32x32x16_bf16 v[32:47], v[136:139], v[104:107], v[32:47]
  v_mul_f32 v64, v48, v48
  v_mul_f32 v65, v49, v49
  v_mul_f32 v66, v50, v50
  v_mul_f32 v67, v51, v51
  v_mul_f32 v68, v52, v52
  v_mul_f32 v69, v53, v53
  v_mul_f32 v70, v54, v54
  v_mul_f32 v71, v55, v55
  v_fma_f32 v64, v64, v14, v13
  v_fma_f32 v65, v65, v14, v13
  v_fma_f32 v66, v66, v14, v13
  v_fma_f32 v67, v67, v14, v13
  v_fma_f32 v68, v68, v14, v13
  v_fma_f32 v69, v69, v14, v13
  v_fma_f32 v70, v70, v14, v13
  v_fma_f32 v71, v71, v14, v13
  ds_read_b64_tr_b16 v[100:101], v6 offset:18432
  ds_read_b64_tr_b16 v[102:103], v6 offset:18944
  v_mfma_f32_32x32x16_bf16 v[32:47], v[140:143], v[108:111], v[32:47]
  v_mul_f32 v64, v64, v48
  v_mul_f32 v65, v65, v49
  v_mul_f32 v66, v66, v50
  v_mul_f32 v67, v67, v51
  v_mul_f32 v68, v68, v52
  v_mul_f32 v69, v69, v53
  v_mul_f32 v70, v70, v54
  v_mul_f32 v71, v71, v55
  v_exp_f32 v64, v64
  v_exp_f32 v65, v65
  v_exp_f32 v66, v66
  v_exp_f32 v67, v67
  ds_read_b64_tr_b16 v[104:105], v6 offset:20480
  ds_read_b64_tr_b16 v[106:107], v6 offset:20992
  s_waitcnt lgkmcnt(10)
  v_mfma_f32_32x32x16_bf16 v[32:47], v[144:147], v[112:115], v[32:47]
  v_exp_f32 v68, v68
  v_exp_f32 v69, v69
  v_exp_f32 v70, v70
  v_exp_f32 v71, v71
  v_fma_f32 v64, v64, v15, v15
  v_fma_f32 v65, v65, v15, v15
  v_fma_f32 v66, v66, v15, v15
  v_fma_f32 v67, v67, v15, v15
  v_fma_f32 v68, v68, v15, v15
  v_fma_f32 v69, v69, v15, v15
  v_fma_f32 v70, v70, v15, v15
  ds_read_b64_tr_b16 v[108:109], v6 offset:22528
  ds_read_b64_tr_b16 v[110:111], v6 offset:23040
  v_mfma_f32_32x32x16_bf16 v[32:47], v[148:151], v[116:119], v[32:47]
  v_fma_f32 v71, v71, v15, v15
  v_rcp_f32 v64, v64
  v_rcp_f32 v65, v65
  v_rcp_f32 v66, v66
  v_rcp_f32 v67, v67
  v_rcp_f32 v68, v68
  v_rcp_f32 v69, v69
  v_rcp_f32 v70, v70
  ds_read_b64_tr_b16 v[112:113], v6 offset:24576
  ds_read_b64_tr_b16 v[114:115], v6 offset:25088
  s_waitcnt lgkmcnt(10)
  v_mfma_f32_32x32x16_bf16 v[32:47], v[152:155], v[120:123], v[32:47]
  v_rcp_f32 v71, v71
  v_mul_f32 v48, v48, v64
  v_mul_f32 v49, v49, v65
  v_mul_f32 v50, v50, v66
  v_mul_f32 v51, v51, v67
  v_mul_f32 v52, v52, v68
  v_mul_f32 v53, v53, v69
  v_mul_f32 v54, v54, v70
  v_mul_f32 v55, v55, v71
  v_cvt_pk_bf16_f32 v72, v48, v49
  v_cvt_pk_bf16_f32 v73, v50, v51
  v_cvt_pk_bf16_f32 v74, v52, v53
  v_cvt_pk_bf16_f32 v75, v54, v55
  buffer_store_dwordx4 v[72:75], v21, s[60:63], s12 offen sc1
  ds_read_b64_tr_b16 v[116:117], v6 offset:26624
  ds_read_b64_tr_b16 v[118:119], v6 offset:27136
  v_mfma_f32_32x32x16_bf16 v[32:47], v[156:159], v[124:127], v[32:47]
  v_mul_f32 v64, v56, v56
  v_mul_f32 v65, v57, v57
  v_mul_f32 v66, v58, v58
  v_mul_f32 v67, v59, v59
  v_mul_f32 v68, v60, v60
  v_mul_f32 v69, v61, v61
  v_mul_f32 v70, v62, v62
  v_mul_f32 v71, v63, v63
  v_fma_f32 v64, v64, v14, v13
  v_fma_f32 v65, v65, v14, v13
  v_fma_f32 v66, v66, v14, v13
  v_fma_f32 v67, v67, v14, v13
  v_fma_f32 v68, v68, v14, v13
  v_fma_f32 v69, v69, v14, v13
  v_fma_f32 v70, v70, v14, v13
  v_fma_f32 v71, v71, v14, v13
  ds_read_b64_tr_b16 v[120:121], v6 offset:28672
  ds_read_b64_tr_b16 v[122:123], v6 offset:29184
  s_waitcnt lgkmcnt(10)
  v_mfma_f32_32x32x16_bf16 v[32:47], v[160:163], v[96:99], v[32:47]
  v_mul_f32 v64, v64, v56
  v_mul_f32 v65, v65, v57
  v_mul_f32 v66, v66, v58
  v_mul_f32 v67, v67, v59
  v_mul_f32 v68, v68, v60
  v_mul_f32 v69, v69, v61
  v_mul_f32 v70, v70, v62
  v_mul_f32 v71, v71, v63
  v_exp_f32 v64, v64
  v_exp_f32 v65, v65
  v_exp_f32 v66, v66
  v_exp_f32 v67, v67
  ds_read_b64_tr_b16 v[124:125], v6 offset:30720
  ds_read_b64_tr_b16 v[126:127], v6 offset:31232
  v_mfma_f32_32x32x16_bf16 v[32:47], v[164:167], v[100:103], v[32:47]
  v_exp_f32 v68, v68
  v_exp_f32 v69, v69
  v_exp_f32 v70, v70
  v_exp_f32 v71, v71
  v_fma_f32 v64, v64, v15, v15
  v_fma_f32 v65, v65, v15, v15
  v_fma_f32 v66, v66, v15, v15
  v_fma_f32 v67, v67, v15, v15
  v_fma_f32 v68, v68, v15, v15
  v_fma_f32 v69, v69, v15, v15
  v_fma_f32 v70, v70, v15, v15
  s_waitcnt lgkmcnt(8)
  v_mfma_f32_32x32x16_bf16 v[32:47], v[168:171], v[104:107], v[32:47]
  v_fma_f32 v71, v71, v15, v15
  v_rcp_f32 v64, v64
  v_rcp_f32 v65, v65
  v_rcp_f32 v66, v66
  v_rcp_f32 v67, v67
  v_rcp_f32 v68, v68
  v_rcp_f32 v69, v69
  v_rcp_f32 v70, v70
  v_mfma_f32_32x32x16_bf16 v[32:47], v[172:175], v[108:111], v[32:47]
  v_rcp_f32 v71, v71
  v_mul_f32 v56, v56, v64
  v_mul_f32 v57, v57, v65
  v_mul_f32 v58, v58, v66
  v_mul_f32 v59, v59, v67
  v_mul_f32 v60, v60, v68
  v_mul_f32 v61, v61, v69
  v_mul_f32 v62, v62, v70
  v_mul_f32 v63, v63, v71
  v_cvt_pk_bf16_f32 v76, v56, v57
  v_cvt_pk_bf16_f32 v77, v58, v59
  v_cvt_pk_bf16_f32 v78, v60, v61
  v_cvt_pk_bf16_f32 v79, v62, v63
  buffer_store_dwordx4 v[76:79], v21, s[60:63], s12 offen offset:1024 sc1
  s_waitcnt lgkmcnt(4)
  v_mfma_f32_32x32x16_bf16 v[32:47], v[176:179], v[112:115], v[32:47]
  s_waitcnt lgkmcnt(0)
  s_barrier
  ds_read_b64_tr_b16 v[96:97], v6 offset:32768
  ds_read_b64_tr_b16 v[98:99], v6 offset:33280
  ds_read_b64_tr_b16 v[100:101], v6 offset:34816
  ds_read_b64_tr_b16 v[102:103], v6 offset:35328
  ds_read_b64_tr_b16 v[104:105], v6 offset:36864
  ds_read_b64_tr_b16 v[106:107], v6 offset:37376
  ds_read_b64_tr_b16 v[108:109], v6 offset:38912
  ds_read_b64_tr_b16 v[110:111], v6 offset:39424
  v_mfma_f32_32x32x16_bf16 v[32:47], v[180:183], v[116:119], v[32:47]
  ds_read_b64_tr_b16 v[112:113], v6 offset:40960
  ds_read_b64_tr_b16 v[114:115], v6 offset:41472
  v_mfma_f32_32x32x16_bf16 v[32:47], v[184:187], v[120:123], v[32:47]
  ds_read_b64_tr_b16 v[116:117], v6 offset:43008
  ds_read_b64_tr_b16 v[118:119], v6 offset:43520
  v_mfma_f32_32x32x16_bf16 v[32:47], v[188:191], v[124:127], v[32:47]
  ds_read_b64_tr_b16 v[120:121], v6 offset:45056
  ds_read_b64_tr_b16 v[122:123], v6 offset:45568
  s_waitcnt lgkmcnt(10)
  v_mfma_f32_32x32x16_bf16 v[32:47], v[192:195], v[96:99], v[32:47]
  ds_read_b64_tr_b16 v[124:125], v6 offset:47104
  ds_read_b64_tr_b16 v[126:127], v6 offset:47616
  v_mfma_f32_32x32x16_bf16 v[32:47], v[196:199], v[100:103], v[32:47]
  ds_read_b64_tr_b16 v[96:97], v6 offset:49152
  ds_read_b64_tr_b16 v[98:99], v6 offset:49664
  s_waitcnt lgkmcnt(10)
  v_mfma_f32_32x32x16_bf16 v[32:47], v[200:203], v[104:107], v[32:47]
  ds_read_b64_tr_b16 v[100:101], v6 offset:51200
  ds_read_b64_tr_b16 v[102:103], v6 offset:51712
  v_mfma_f32_32x32x16_bf16 v[32:47], v[204:207], v[108:111], v[32:47]
  ds_read_b64_tr_b16 v[104:105], v6 offset:53248
  ds_read_b64_tr_b16 v[106:107], v6 offset:53760
  s_waitcnt lgkmcnt(10)
  v_mfma_f32_32x32x16_bf16 v[32:47], v[208:211], v[112:115], v[32:47]
  ds_read_b64_tr_b16 v[108:109], v6 offset:55296
  ds_read_b64_tr_b16 v[110:111], v6 offset:55808
  v_mfma_f32_32x32x16_bf16 v[32:47], v[212:215], v[116:119], v[32:47]
  ds_read_b64_tr_b16 v[112:113], v6 offset:57344
  ds_read_b64_tr_b16 v[114:115], v6 offset:57856
  s_waitcnt lgkmcnt(10)
  v_mfma_f32_32x32x16_bf16 v[32:47], v[216:219], v[120:123], v[32:47]
  ds_read_b64_tr_b16 v[116:117], v6 offset:59392
  ds_read_b64_tr_b16 v[118:119], v6 offset:59904
  v_mfma_f32_32x32x16_bf16 v[32:47], v[220:223], v[124:127], v[32:47]
  ds_read_b64_tr_b16 v[120:121], v6 offset:61440
  ds_read_b64_tr_b16 v[122:123], v6 offset:61952
  s_waitcnt lgkmcnt(10)
  v_mfma_f32_32x32x16_bf16 v[32:47], v[224:227], v[96:99], v[32:47]
  ds_read_b64_tr_b16 v[124:125], v6 offset:63488
  ds_read_b64_tr_b16 v[126:127], v6 offset:64000
  v_mfma_f32_32x32x16_bf16 v[32:47], v[228:231], v[100:103], v[32:47]
  s_waitcnt lgkmcnt(8)
  v_mfma_f32_32x32x16_bf16 v[32:47], v[232:235], v[104:107], v[32:47]
  s_waitcnt vmcnt(0)
  s_add_u32 s16, s8, 0x1700080
  buffer_store_dword v19, v20, s[60:63], s16 offen sc1
  v_mfma_f32_32x32x16_bf16 v[32:47], v[236:239], v[108:111], v[32:47]
  s_waitcnt lgkmcnt(4)
  v_mfma_f32_32x32x16_bf16 v[32:47], v[240:243], v[112:115], v[32:47]
  s_waitcnt lgkmcnt(0)
  s_barrier
  ds_read_b64_tr_b16 v[96:97], v7 offset:0
  ds_read_b64_tr_b16 v[98:99], v7 offset:512
  ds_read_b64_tr_b16 v[100:101], v7 offset:2048
  ds_read_b64_tr_b16 v[102:103], v7 offset:2560
  ds_read_b64_tr_b16 v[104:105], v7 offset:4096
  ds_read_b64_tr_b16 v[106:107], v7 offset:4608
  ds_read_b64_tr_b16 v[108:109], v7 offset:6144
  ds_read_b64_tr_b16 v[110:111], v7 offset:6656
  v_mfma_f32_32x32x16_bf16 v[32:47], v[244:247], v[116:119], v[32:47]
  ds_read_b64_tr_b16 v[112:113], v7 offset:8192
  ds_read_b64_tr_b16 v[114:115], v7 offset:8704
  v_mfma_f32_32x32x16_bf16 v[32:47], v[248:251], v[120:123], v[32:47]
  ds_read_b64_tr_b16 v[116:117], v7 offset:10240
  ds_read_b64_tr_b16 v[118:119], v7 offset:10752
  v_mfma_f32_32x32x16_bf16 v[48:63], v[252:255], v[124:127], v[32:47]
  ds_read_b64_tr_b16 v[120:121], v7 offset:12288
  ds_read_b64_tr_b16 v[122:123], v7 offset:12800
  s_waitcnt lgkmcnt(10)
  s_nop 3
  v_mfma_f32_32x32x16_bf16 v[32:47], v[128:131], v[96:99], 0
  ds_read_b64_tr_b16 v[124:125], v7 offset:14336
  ds_read_b64_tr_b16 v[126:127], v7 offset:14848
  v_mfma_f32_32x32x16_bf16 v[32:47], v[132:135], v[100:103], v[32:47]
  ds_read_b64_tr_b16 v[96:97], v7 offset:16384
  ds_read_b64_tr_b16 v[98:99], v7 offset:16896
  s_waitcnt lgkmcnt(10)
  v_mfma_f32_32x32x16_bf16 v[32:47], v[136:139], v[104:107], v[32:47]
  v_mul_f32 v64, 0x3fb8aa3b, v48
  v_mul_f32 v65, 0x3fb8aa3b, v49
  v_mul_f32 v66, 0x3fb8aa3b, v50
  v_mul_f32 v67, 0x3fb8aa3b, v51
  v_mul_f32 v68, 0x3fb8aa3b, v52
  ds_read_b64_tr_b16 v[100:101], v7 offset:18432
  ds_read_b64_tr_b16 v[102:103], v7 offset:18944
  v_mfma_f32_32x32x16_bf16 v[32:47], v[140:143], v[108:111], v[32:47]
  v_mul_f32 v69, 0x3fb8aa3b, v53
  v_mul_f32 v70, 0x3fb8aa3b, v54
  v_mul_f32 v71, 0x3fb8aa3b, v55
  v_mul_f32 v72, 0x3fb8aa3b, v56
  ds_read_b64_tr_b16 v[104:105], v7 offset:20480
  ds_read_b64_tr_b16 v[106:107], v7 offset:20992
  s_waitcnt lgkmcnt(10)
  v_mfma_f32_32x32x16_bf16 v[32:47], v[144:147], v[112:115], v[32:47]
  v_mul_f32 v73, 0x3fb8aa3b, v57
  v_mul_f32 v74, 0x3fb8aa3b, v58
  v_mul_f32 v75, 0x3fb8aa3b, v59
  v_mul_f32 v76, 0x3fb8aa3b, v60
  v_mul_f32 v77, 0x3fb8aa3b, v61
  ds_read_b64_tr_b16 v[108:109], v7 offset:22528
  ds_read_b64_tr_b16 v[110:111], v7 offset:23040
  v_mfma_f32_32x32x16_bf16 v[32:47], v[148:151], v[116:119], v[32:47]
  v_mul_f32 v78, 0x3fb8aa3b, v62
  v_mul_f32 v79, 0x3fb8aa3b, v63
  v_add_f32 v48, s13, v48
  v_add_f32 v49, s13, v49
  v_add_f32 v50, s13, v50
  ds_read_b64_tr_b16 v[112:113], v7 offset:24576
  ds_read_b64_tr_b16 v[114:115], v7 offset:25088
  s_waitcnt lgkmcnt(10)
  v_mfma_f32_32x32x16_bf16 v[32:47], v[152:155], v[120:123], v[32:47]
  v_add_f32 v51, s13, v51
  v_add_f32 v52, s13, v52
  v_add_f32 v53, s13, v53
  v_add_f32 v54, s13, v54
  v_add_f32 v55, s13, v55
  ds_read_b64_tr_b16 v[116:117], v7 offset:26624
  ds_read_b64_tr_b16 v[118:119], v7 offset:27136
  v_mfma_f32_32x32x16_bf16 v[32:47], v[156:159], v[124:127], v[32:47]
  v_add_f32 v56, s13, v56
  v_add_f32 v57, s13, v57
  v_add_f32 v58, s13, v58
  v_add_f32 v59, s13, v59
  ds_read_b64_tr_b16 v[120:121], v7 offset:28672
  ds_read_b64_tr_b16 v[122:123], v7 offset:29184
  s_waitcnt lgkmcnt(10)
  v_mfma_f32_32x32x16_bf16 v[32:47], v[160:163], v[96:99], v[32:47]
  v_add_f32 v60, s13, v60
  v_add_f32 v61, s13, v61
  v_add_f32 v62, s13, v62
  v_add_f32 v63, s13, v63
  v_exp_f32 v64, v64 clamp
  ds_read_b64_tr_b16 v[124:125], v7 offset:30720
  ds_read_b64_tr_b16 v[126:127], v7 offset:31232
  v_mfma_f32_32x32x16_bf16 v[32:47], v[164:167], v[100:103], v[32:47]
  v_exp_f32 v65, v65 clamp
  v_exp_f32 v66, v66 clamp
  s_waitcnt lgkmcnt(8)
  v_mfma_f32_32x32x16_bf16 v[32:47], v[168:171], v[104:107], v[32:47]
  v_exp_f32 v67, v67 clamp
  v_exp_f32 v68, v68 clamp
  v_mfma_f32_32x32x16_bf16 v[32:47], v[172:175], v[108:111], v[32:47]
  v_exp_f32 v69, v69 clamp
  v_exp_f32 v70, v70 clamp
  v_exp_f32 v71, v71 clamp
  s_waitcnt lgkmcnt(4)
  v_mfma_f32_32x32x16_bf16 v[32:47], v[176:179], v[112:115], v[32:47]
  v_exp_f32 v72, v72 clamp
  v_exp_f32 v73, v73 clamp
  s_waitcnt lgkmcnt(0)
  s_barrier
  ds_read_b64_tr_b16 v[96:97], v7 offset:32768
  ds_read_b64_tr_b16 v[98:99], v7 offset:33280
  ds_read_b64_tr_b16 v[100:101], v7 offset:34816
  ds_read_b64_tr_b16 v[102:103], v7 offset:35328
  ds_read_b64_tr_b16 v[104:105], v7 offset:36864
  ds_read_b64_tr_b16 v[106:107], v7 offset:37376
  ds_read_b64_tr_b16 v[108:109], v7 offset:38912
  ds_read_b64_tr_b16 v[110:111], v7 offset:39424
  v_mfma_f32_32x32x16_bf16 v[32:47], v[180:183], v[116:119], v[32:47]
  v_exp_f32 v74, v74 clamp
  v_exp_f32 v75, v75 clamp
  ds_read_b64_tr_b16 v[112:113], v7 offset:40960
  ds_read_b64_tr_b16 v[114:115], v7 offset:41472
  v_mfma_f32_32x32x16_bf16 v[32:47], v[184:187], v[120:123], v[32:47]
  v_exp_f32 v76, v76 clamp
  v_exp_f32 v77, v77 clamp
  v_exp_f32 v78, v78 clamp
  ds_read_b64_tr_b16 v[116:117], v7 offset:43008
  ds_read_b64_tr_b16 v[118:119], v7 offset:43520
  v_mfma_f32_32x32x16_bf16 v[32:47], v[188:191], v[124:127], v[32:47]
  v_exp_f32 v79, v79 clamp
  v_max_f32 v48, s13, v48
  v_max_f32 v49, s13, v49
  ds_read_b64_tr_b16 v[120:121], v7 offset:45056
  ds_read_b64_tr_b16 v[122:123], v7 offset:45568
  s_waitcnt lgkmcnt(10)
  v_mfma_f32_32x32x16_bf16 v[32:47], v[192:195], v[96:99], v[32:47]
  v_max_f32 v50, s13, v50
  v_max_f32 v51, s13, v51
  v_max_f32 v52, s13, v52
  v_max_f32 v53, s13, v53
  v_max_f32 v54, s13, v54
  ds_read_b64_tr_b16 v[124:125], v7 offset:47104
  ds_read_b64_tr_b16 v[126:127], v7 offset:47616
  v_mfma_f32_32x32x16_bf16 v[32:47], v[196:199], v[100:103], v[32:47]
  v_max_f32 v55, s13, v55
  v_max_f32 v56, s13, v56
  v_max_f32 v57, s13, v57
  v_max_f32 v58, s13, v58
  v_max_f32 v59, s13, v59
  ds_read_b64_tr_b16 v[96:97], v7 offset:49152
  ds_read_b64_tr_b16 v[98:99], v7 offset:49664
  s_waitcnt lgkmcnt(10)
  v_mfma_f32_32x32x16_bf16 v[32:47], v[200:203], v[104:107], v[32:47]
  v_max_f32 v60, s13, v60
  v_max_f32 v61, s13, v61
  v_max_f32 v62, s13, v62
  v_max_f32 v63, s13, v63
  ds_read_b64_tr_b16 v[100:101], v7 offset:51200
  ds_read_b64_tr_b16 v[102:103], v7 offset:51712
  v_mfma_f32_32x32x16_bf16 v[32:47], v[204:207], v[108:111], v[32:47]
  v_add_f32 v48, v48, v64
  v_add_f32 v49, v49, v65
  v_add_f32 v50, v50, v66
  v_add_f32 v51, v51, v67
  v_add_f32 v52, v52, v68
  ds_read_b64_tr_b16 v[104:105], v7 offset:53248
  ds_read_b64_tr_b16 v[106:107], v7 offset:53760
  s_waitcnt lgkmcnt(10)
  v_mfma_f32_32x32x16_bf16 v[32:47], v[208:211], v[112:115], v[32:47]
  v_add_f32 v53, v53, v69
  v_add_f32 v54, v54, v70
  v_add_f32 v55, v55, v71
  v_add_f32 v56, v56, v72
  v_add_f32 v57, v57, v73
  ds_read_b64_tr_b16 v[108:109], v7 offset:55296
  ds_read_b64_tr_b16 v[110:111], v7 offset:55808
  v_mfma_f32_32x32x16_bf16 v[32:47], v[212:215], v[116:119], v[32:47]
  v_add_f32 v58, v58, v74
  v_add_f32 v59, v59, v75
  v_add_f32 v60, v60, v76
  v_add_f32 v61, v61, v77
  v_add_f32 v62, v62, v78
  ds_read_b64_tr_b16 v[112:113], v7 offset:57344
  ds_read_b64_tr_b16 v[114:115], v7 offset:57856
  s_waitcnt lgkmcnt(10)
  v_mfma_f32_32x32x16_bf16 v[32:47], v[216:219], v[120:123], v[32:47]
  v_add_f32 v63, v63, v79
  v_cvt_pk_bf16_f32 v88, v48, v49
  v_cvt_pk_bf16_f32 v89, v50, v51
  v_cvt_pk_bf16_f32 v90, v52, v53
  ds_read_b64_tr_b16 v[116:117], v7 offset:59392
  ds_read_b64_tr_b16 v[118:119], v7 offset:59904
  v_mfma_f32_32x32x16_bf16 v[32:47], v[220:223], v[124:127], v[32:47]
  v_cvt_pk_bf16_f32 v91, v54, v55
  v_cvt_pk_bf16_f32 v92, v56, v57
  v_cvt_pk_bf16_f32 v93, v58, v59
  v_cvt_pk_bf16_f32 v94, v60, v61
  v_cvt_pk_bf16_f32 v95, v62, v63
  ds_read_b64_tr_b16 v[120:121], v7 offset:61440
  ds_read_b64_tr_b16 v[122:123], v7 offset:61952
  s_waitcnt lgkmcnt(10)
  v_mfma_f32_32x32x16_bf16 v[32:47], v[224:227], v[96:99], v[32:47]
  ds_read_b64_tr_b16 v[124:125], v7 offset:63488
  ds_read_b64_tr_b16 v[126:127], v7 offset:64000
  v_mfma_f32_32x32x16_bf16 v[32:47], v[228:231], v[100:103], v[32:47]
  s_waitcnt lgkmcnt(8)
  v_mfma_f32_32x32x16_bf16 v[32:47], v[232:235], v[104:107], v[32:47]
  v_mfma_f32_32x32x16_bf16 v[32:47], v[236:239], v[108:111], v[32:47]
  s_waitcnt lgkmcnt(4)
  v_mfma_f32_32x32x16_bf16 v[32:47], v[240:243], v[112:115], v[32:47]
  v_mfma_f32_32x32x16_bf16 v[32:47], v[244:247], v[116:119], v[32:47]
  s_waitcnt lgkmcnt(0)
  v_mfma_f32_32x32x16_bf16 v[32:47], v[248:251], v[120:123], v[32:47]
  v_mfma_f32_32x32x16_bf16 v[48:63], v[252:255], v[124:127], v[32:47]
  s_nop 11
  v_cvt_pk_bf16_f32 v64, v48, v49
  v_cvt_pk_bf16_f32 v65, v50, v51
  v_cvt_pk_bf16_f32 v66, v52, v53
  v_cvt_pk_bf16_f32 v67, v54, v55
  v_cvt_pk_bf16_f32 v68, v56, v57
  v_cvt_pk_bf16_f32 v69, v58, v59
  v_cvt_pk_bf16_f32 v70, v60, v61
  v_cvt_pk_bf16_f32 v71, v62, v63
  s_mov_b32 s80, 0x0000ffff
  s_mov_b32 s81, 0x0000ffff
  v_cndmask_b32 v72, v30, v64, s[80:81]
  v_cndmask_b32 v73, v30, v65, s[80:81]
  v_cndmask_b32 v74, v30, v66, s[80:81]
  v_cndmask_b32 v75, v30, v67, s[80:81]
  v_cndmask_b32 v76, v30, v68, s[80:81]
  v_cndmask_b32 v77, v30, v69, s[80:81]
  v_cndmask_b32 v78, v30, v70, s[80:81]
  v_cndmask_b32 v79, v30, v71, s[80:81]
  v_cndmask_b32 v64, v64, v30, s[80:81]
  v_cndmask_b32 v65, v65, v30, s[80:81]
  v_cndmask_b32 v66, v66, v30, s[80:81]
  v_cndmask_b32 v67, v67, v30, s[80:81]
  v_cndmask_b32 v68, v68, v30, s[80:81]
  v_cndmask_b32 v69, v69, v30, s[80:81]
  v_cndmask_b32 v70, v70, v30, s[80:81]
  v_cndmask_b32 v71, v71, v30, s[80:81]
  v_mfma_f32_32x32x16_bf16 v[96:111], v[88:91], v[72:75], 0
  v_mfma_f32_32x32x16_bf16 v[112:127], v[88:91], v[64:67], 0
  v_mfma_f32_32x32x16_bf16 v[96:111], v[92:95], v[76:79], v[96:111]
  v_mfma_f32_32x32x16_bf16 v[112:127], v[92:95], v[68:71], v[112:127]
  s_cmp_eq_u32 s30, 0
  s_cbranch_scc1 A_KV0
  s_nop 8
  v_mov_b32 v32, v96
  v_mov_b32 v33, v97
  v_mov_b32 v34, v98
  v_mov_b32 v35, v99
  v_mov_b32 v36, v100
  v_mov_b32 v37, v101
  v_mov_b32 v38, v102
  v_mov_b32 v39, v103
  v_mov_b32 v40, v120
  v_mov_b32 v41, v121
  v_mov_b32 v42, v122
  v_mov_b32 v43, v123
  v_mov_b32 v44, v124
  v_mov_b32 v45, v125
  v_mov_b32 v46, v126
  v_mov_b32 v47, v127
  s_branch A_KV1
A_KV0:
  s_nop 9
  v_mov_b32 v32, v120
  v_mov_b32 v33, v121
  v_mov_b32 v34, v122
  v_mov_b32 v35, v123
  v_mov_b32 v36, v124
  v_mov_b32 v37, v125
  v_mov_b32 v38, v126
  s_nop 2
  v_mov_b32 v39, v127
  v_mov_b32 v40, v96
  v_mov_b32 v41, v97
  v_mov_b32 v42, v98
  v_mov_b32 v43, v99
  v_mov_b32 v44, v100
  v_mov_b32 v45, v101
  v_mov_b32 v46, v102
  v_mov_b32 v47, v103
A_KV1:
  ds_write_b128 v17, v[32:35] offset:2048
  ds_write_b128 v17, v[36:39] offset:3072
  v_xor_b32 v31, 4096, v17
  s_waitcnt lgkmcnt(0)
  s_barrier
  ds_read_b128 v[32:35], v31 offset:2048
  ds_read_b128 v[36:39], v31 offset:3072
  s_add_u32 s72, s4, s30
  s_xor_b32 s72, s72, s3
  s_lshl_b32 s72, s72, 5
  s_add_u32 s72, s72, s27
  s_lshl_b32 s73, s72, 11
  s_add_u32 s73, s73, 0x1200000
  s_lshl_b32 s5, s72, 2
  s_add_u32 s5, s5, 0x1708000
  s_waitcnt lgkmcnt(0)
  v_add_f32 v32, v32, v40
  v_add_f32 v33, v33, v41
  v_add_f32 v34, v34, v42
  v_add_f32 v35, v35, v43
  v_add_f32 v36, v36, v44
  v_add_f32 v37, v37, v45
  v_add_f32 v38, v38, v46
  v_add_f32 v39, v39, v47
  buffer_store_dwordx4 v[32:35], v21, s[60:63], s73 offen sc1
  buffer_store_dwordx4 v[36:39], v21, s[60:63], s73 offen offset:1024 sc1
  ds_read_b64 v[64:65], v18
  v_xor_b32 v31, 16, v18
  ds_read_b64 v[66:67], v31
  v_xor_b32 v31, 32, v18
  ds_read_b64 v[68:69], v31
  v_xor_b32 v31, 48, v18
  ds_read_b64 v[70:71], v31
  s_lshl_b32 s72, s30, 9
  s_add_u32 s72, s72, 155648
  v_lshl_add_u32 v31, v1, 4, s72
  ds_read_b64 v[72:73], v31
  s_waitcnt lgkmcnt(0)
  v_lshlrev_b32 v48, 16, v64
  v_and_b32 v49, 0xffff0000, v64
  v_lshlrev_b32 v50, 16, v65
  v_and_b32 v51, 0xffff0000, v65
  v_lshlrev_b32 v52, 16, v66
  v_and_b32 v53, 0xffff0000, v66
  v_lshlrev_b32 v54, 16, v67
  v_and_b32 v55, 0xffff0000, v67
  v_lshlrev_b32 v56, 16, v68
  v_and_b32 v57, 0xffff0000, v68
  v_lshlrev_b32 v58, 16, v69
  v_and_b32 v59, 0xffff0000, v69
  v_lshlrev_b32 v60, 16, v70
  v_and_b32 v61, 0xffff0000, v70
  v_lshlrev_b32 v62, 16, v71
  v_and_b32 v63, 0xffff0000, v71
  v_fma_f32 v48, v48, v73, v72
  v_fma_f32 v49, v49, v73, v72
  v_fma_f32 v50, v50, v73, v72
  v_fma_f32 v51, v51, v73, v72
  v_fma_f32 v52, v52, v73, v72
  v_fma_f32 v53, v53, v73, v72
  v_fma_f32 v54, v54, v73, v72
  v_fma_f32 v55, v55, v73, v72
  v_fma_f32 v56, v56, v73, v72
  v_fma_f32 v57, v57, v73, v72
  v_fma_f32 v58, v58, v73, v72
  v_fma_f32 v59, v59, v73, v72
  v_fma_f32 v60, v60, v73, v72
  v_fma_f32 v61, v61, v73, v72
  v_fma_f32 v62, v62, v73, v72
  v_fma_f32 v63, v63, v73, v72
  s_barrier
  ds_read_b128 v[64:67], v10 offset:0
  ds_read_b64_tr_b16 v[96:97], v8 offset:0
  ds_read_b64_tr_b16 v[98:99], v8 offset:1024
  ds_read_b128 v[68:71], v10 offset:1024
  ds_read_b64_tr_b16 v[100:101], v8 offset:2048
  ds_read_b64_tr_b16 v[102:103], v8 offset:3072
  ds_read_b128 v[72:75], v10 offset:2048
  ds_read_b64_tr_b16 v[104:105], v8 offset:4096
  ds_read_b64_tr_b16 v[106:107], v8 offset:5120
  ds_read_b128 v[76:79], v10 offset:3072
  ds_read_b64_tr_b16 v[108:109], v8 offset:6144
  ds_read_b64_tr_b16 v[110:111], v8 offset:7168
  ds_read_b128 v[80:83], v10 offset:16384
  ds_read_b64_tr_b16 v[112:113], v8 offset:16384
  ds_read_b64_tr_b16 v[114:115], v8 offset:17408
  s_waitcnt lgkmcnt(9)
  v_mfma_f32_32x32x16_bf16 v[32:47], v[96:99], v[64:67], v[48:63]
  ds_read_b128 v[84:87], v10 offset:17408
  ds_read_b64_tr_b16 v[116:117], v8 offset:18432
  ds_read_b64_tr_b16 v[118:119], v8 offset:19456
  v_mfma_f32_32x32x16_bf16 v[32:47], v[100:103], v[68:71], v[32:47]
  ds_read_b128 v[88:91], v10 offset:18432
  ds_read_b64_tr_b16 v[120:121], v8 offset:20480
  ds_read_b64_tr_b16 v[122:123], v8 offset:21504
  s_waitcnt lgkmcnt(9)
  v_mfma_f32_32x32x16_bf16 v[32:47], v[104:107], v[72:75], v[32:47]
  ds_read_b128 v[92:95], v10 offset:19456
  ds_read_b64_tr_b16 v[124:125], v8 offset:22528
  ds_read_b64_tr_b16 v[126:127], v8 offset:23552
  v_mfma_f32_32x32x16_bf16 v[32:47], v[108:111], v[76:79], v[32:47]
  s_waitcnt lgkmcnt(6)
  v_mfma_f32_32x32x16_bf16 v[32:47], v[112:115], v[80:83], v[32:47]
  v_mfma_f32_32x32x16_bf16 v[32:47], v[116:119], v[84:87], v[32:47]
  s_waitcnt lgkmcnt(0)
  s_barrier
  ds_read_b128 v[64:67], v10 offset:32768
  ds_read_b64_tr_b16 v[96:97], v8 offset:32768
  ds_read_b64_tr_b16 v[98:99], v8 offset:33792
  ds_read_b128 v[68:71], v10 offset:33792
  ds_read_b64_tr_b16 v[100:101], v8 offset:34816
  ds_read_b64_tr_b16 v[102:103], v8 offset:35840
  ds_read_b128 v[72:75], v10 offset:34816
  ds_read_b64_tr_b16 v[104:105], v8 offset:36864
  ds_read_b64_tr_b16 v[106:107], v8 offset:37888
  v_mfma_f32_32x32x16_bf16 v[32:47], v[120:123], v[88:91], v[32:47]
  ds_read_b128 v[76:79], v10 offset:35840
  ds_read_b64_tr_b16 v[108:109], v8 offset:38912
  ds_read_b64_tr_b16 v[110:111], v8 offset:39936
  v_mfma_f32_32x32x16_bf16 v[32:47], v[124:127], v[92:95], v[32:47]
  ds_read_b128 v[80:83], v10 offset:49152
  ds_read_b64_tr_b16 v[112:113], v8 offset:49152
  ds_read_b64_tr_b16 v[114:115], v8 offset:50176
  s_waitcnt lgkmcnt(12)
  v_mfma_f32_32x32x16_bf16 v[32:47], v[96:99], v[64:67], v[32:47]
  ds_read_b128 v[84:87], v10 offset:50176
  ds_read_b64_tr_b16 v[116:117], v8 offset:51200
  ds_read_b64_tr_b16 v[118:119], v8 offset:52224
  s_waitcnt lgkmcnt(9)
  v_mfma_f32_32x32x16_bf16 v[32:47], v[100:103], v[68:71], v[32:47]
  ds_read_b128 v[88:91], v10 offset:51200
  ds_read_b64_tr_b16 v[120:121], v8 offset:53248
  ds_read_b64_tr_b16 v[122:123], v8 offset:54272
  v_mfma_f32_32x32x16_bf16 v[32:47], v[104:107], v[72:75], v[32:47]
  ds_read_b128 v[92:95], v10 offset:52224
  ds_read_b64_tr_b16 v[124:125], v8 offset:55296
  ds_read_b64_tr_b16 v[126:127], v8 offset:56320
  s_waitcnt lgkmcnt(9)
  v_mfma_f32_32x32x16_bf16 v[32:47], v[108:111], v[76:79], v[32:47]
  v_mfma_f32_32x32x16_bf16 v[32:47], v[112:115], v[80:83], v[32:47]
  s_waitcnt lgkmcnt(3)
  v_mfma_f32_32x32x16_bf16 v[32:47], v[116:119], v[84:87], v[32:47]
  s_waitcnt lgkmcnt(0)
  s_barrier
  ds_read_b128 v[64:67], v11 offset:0
  ds_read_b64_tr_b16 v[96:97], v9 offset:0
  ds_read_b64_tr_b16 v[98:99], v9 offset:1024
  ds_read_b128 v[68:71], v11 offset:1024
  ds_read_b64_tr_b16 v[100:101], v9 offset:2048
  ds_read_b64_tr_b16 v[102:103], v9 offset:3072
  ds_read_b128 v[72:75], v11 offset:2048
  ds_read_b64_tr_b16 v[104:105], v9 offset:4096
  ds_read_b64_tr_b16 v[106:107], v9 offset:5120
  v_mfma_f32_32x32x16_bf16 v[32:47], v[120:123], v[88:91], v[32:47]
  ds_read_b128 v[76:79], v11 offset:3072
  ds_read_b64_tr_b16 v[108:109], v9 offset:6144
  ds_read_b64_tr_b16 v[110:111], v9 offset:7168
  v_mfma_f32_32x32x16_bf16 v[32:47], v[124:127], v[92:95], v[32:47]
  ds_read_b128 v[80:83], v11 offset:16384
  ds_read_b64_tr_b16 v[112:113], v9 offset:16384
  ds_read_b64_tr_b16 v[114:115], v9 offset:17408
  s_waitcnt lgkmcnt(12)
  v_mfma_f32_32x32x16_bf16 v[32:47], v[96:99], v[64:67], v[32:47]
  ds_read_b128 v[84:87], v11 offset:17408
  ds_read_b64_tr_b16 v[116:117], v9 offset:18432
  ds_read_b64_tr_b16 v[118:119], v9 offset:19456
  s_waitcnt lgkmcnt(9)
  v_mfma_f32_32x32x16_bf16 v[32:47], v[100:103], v[68:71], v[32:47]
  ds_read_b128 v[88:91], v11 offset:18432
  ds_read_b64_tr_b16 v[120:121], v9 offset:20480
  ds_read_b64_tr_b16 v[122:123], v9 offset:21504
  v_mfma_f32_32x32x16_bf16 v[32:47], v[104:107], v[72:75], v[32:47]
  ds_read_b128 v[92:95], v11 offset:19456
  ds_read_b64_tr_b16 v[124:125], v9 offset:22528
  ds_read_b64_tr_b16 v[126:127], v9 offset:23552
  s_waitcnt lgkmcnt(9)
  v_mfma_f32_32x32x16_bf16 v[32:47], v[108:111], v[76:79], v[32:47]
  v_mfma_f32_32x32x16_bf16 v[32:47], v[112:115], v[80:83], v[32:47]
  s_waitcnt lgkmcnt(3)
  v_mfma_f32_32x32x16_bf16 v[32:47], v[116:119], v[84:87], v[32:47]
  s_waitcnt lgkmcnt(0)
  s_barrier
  ds_read_b128 v[64:67], v11 offset:32768
  ds_read_b64_tr_b16 v[96:97], v9 offset:32768
  ds_read_b64_tr_b16 v[98:99], v9 offset:33792
  ds_read_b128 v[68:71], v11 offset:33792
  ds_read_b64_tr_b16 v[100:101], v9 offset:34816
  ds_read_b64_tr_b16 v[102:103], v9 offset:35840
  ds_read_b128 v[72:75], v11 offset:34816
  ds_read_b64_tr_b16 v[104:105], v9 offset:36864
  ds_read_b64_tr_b16 v[106:107], v9 offset:37888
  v_mfma_f32_32x32x16_bf16 v[32:47], v[120:123], v[88:91], v[32:47]
  ds_read_b128 v[76:79], v11 offset:35840
  ds_read_b64_tr_b16 v[108:109], v9 offset:38912
  ds_read_b64_tr_b16 v[110:111], v9 offset:39936
  v_mfma_f32_32x32x16_bf16 v[32:47], v[124:127], v[92:95], v[32:47]
  ds_read_b128 v[80:83], v11 offset:49152
  ds_read_b64_tr_b16 v[112:113], v9 offset:49152
  ds_read_b64_tr_b16 v[114:115], v9 offset:50176
  s_waitcnt lgkmcnt(12)
  v_mfma_f32_32x32x16_bf16 v[32:47], v[96:99], v[64:67], v[32:47]
  ds_read_b128 v[84:87], v11 offset:50176
  ds_read_b64_tr_b16 v[116:117], v9 offset:51200
  ds_read_b64_tr_b16 v[118:119], v9 offset:52224
  s_waitcnt lgkmcnt(9)
  v_mfma_f32_32x32x16_bf16 v[32:47], v[100:103], v[68:71], v[32:47]
  ds_read_b128 v[88:91], v11 offset:51200
  ds_read_b64_tr_b16 v[120:121], v9 offset:53248
  ds_read_b64_tr_b16 v[122:123], v9 offset:54272
  v_mfma_f32_32x32x16_bf16 v[32:47], v[104:107], v[72:75], v[32:47]
  ds_read_b128 v[92:95], v11 offset:52224
  ds_read_b64_tr_b16 v[124:125], v9 offset:55296
  ds_read_b64_tr_b16 v[126:127], v9 offset:56320
  s_waitcnt lgkmcnt(9)
  v_mfma_f32_32x32x16_bf16 v[32:47], v[108:111], v[76:79], v[32:47]
  v_mfma_f32_32x32x16_bf16 v[32:47], v[112:115], v[80:83], v[32:47]
  s_waitcnt lgkmcnt(3)
  v_mfma_f32_32x32x16_bf16 v[32:47], v[116:119], v[84:87], v[32:47]
  v_mfma_f32_32x32x16_bf16 v[32:47], v[120:123], v[88:91], v[32:47]
  s_waitcnt lgkmcnt(0)
  v_mfma_f32_32x32x16_bf16 v[32:47], v[124:127], v[92:95], v[32:47]
  s_waitcnt vmcnt(0)
  buffer_store_dword v19, v20, s[60:63], s5 offen sc1
  s_nop 9
  v_cvt_pk_bf16_f32 v22, v32, v33
  v_cvt_pk_bf16_f32 v23, v34, v35
  v_cvt_pk_bf16_f32 v24, v36, v37
  v_cvt_pk_bf16_f32 v25, v38, v39
  v_cvt_pk_bf16_f32 v26, v40, v41
  v_cvt_pk_bf16_f32 v27, v42, v43
  v_cvt_pk_bf16_f32 v28, v44, v45
  v_cvt_pk_bf16_f32 v29, v46, v47
  s_add_u32 s72, s7, 0x400000
  buffer_store_dwordx4 v[22:25], v21, s[60:63], s72 offen sc1
  buffer_store_dwordx4 v[26:29], v21, s[60:63], s72 offen offset:1024 sc1
  v_mov_b32 v64, 0
  v_mov_b32 v65, 0
  v_dot2_f32_bf16 v64, v22, v30, v64
  v_dot2_f32_bf16 v65, v22, v22, v65
  v_dot2_f32_bf16 v64, v23, v30, v64
  v_dot2_f32_bf16 v65, v23, v23, v65
  v_dot2_f32_bf16 v64, v24, v30, v64
  v_dot2_f32_bf16 v65, v24, v24, v65
  v_dot2_f32_bf16 v64, v25, v30, v64
  v_dot2_f32_bf16 v65, v25, v25, v65
  v_dot2_f32_bf16 v64, v26, v30, v64
  v_dot2_f32_bf16 v65, v26, v26, v65
  v_dot2_f32_bf16 v64, v27, v30, v64
  v_dot2_f32_bf16 v65, v27, v27, v65
  v_dot2_f32_bf16 v64, v28, v30, v64
  v_dot2_f32_bf16 v65, v28, v28, v65
  v_dot2_f32_bf16 v64, v29, v30, v64
  v_dot2_f32_bf16 v65, v29, v29, v65
  s_lshl_b32 s72, s27, 4
  s_lshl_b32 s73, s28, 1
  s_add_u32 s72, s72, s73
  s_add_u32 s72, s72, s31
  s_lshl_b32 s72, s72, 1
  s_add_u32 s72, s72, s30
  s_lshl_b32 s72, s72, 8
  s_add_u32 s72, s72, 0x1500000
  v_permlane32_swap_b32 v64, v65
  v_add_f32 v64, v64, v65
  buffer_store_dword v64, v3, s[60:63], s72 offen sc1
  s_add_u32 s9, s8, 0x1702000
  s_barrier
  ds_read_b64_tr_b16 v[96:97], v6 offset:0
  ds_read_b64_tr_b16 v[98:99], v6 offset:512
  ds_read_b64_tr_b16 v[100:101], v6 offset:2048
  ds_read_b64_tr_b16 v[102:103], v6 offset:2560
  ds_read_b64_tr_b16 v[104:105], v6 offset:4096
  ds_read_b64_tr_b16 v[106:107], v6 offset:4608
  ds_read_b64_tr_b16 v[108:109], v6 offset:6144
  ds_read_b64_tr_b16 v[110:111], v6 offset:6656
  ds_read_b64_tr_b16 v[112:113], v6 offset:8192
  ds_read_b64_tr_b16 v[114:115], v6 offset:8704
  ds_read_b64_tr_b16 v[116:117], v6 offset:10240
  ds_read_b64_tr_b16 v[118:119], v6 offset:10752
  ds_read_b64_tr_b16 v[120:121], v6 offset:12288
  ds_read_b64_tr_b16 v[122:123], v6 offset:12800
  s_waitcnt lgkmcnt(10)
  v_mfma_f32_32x32x16_bf16 v[32:47], v[96:99], v[128:131], 0
  ds_read_b64_tr_b16 v[124:125], v6 offset:14336
  ds_read_b64_tr_b16 v[126:127], v6 offset:14848
  v_mfma_f32_32x32x16_bf16 v[32:47], v[100:103], v[132:135], v[32:47]
  ds_read_b64_tr_b16 v[96:97], v6 offset:16384
  ds_read_b64_tr_b16 v[98:99], v6 offset:16896
  s_waitcnt lgkmcnt(10)
  v_mfma_f32_32x32x16_bf16 v[32:47], v[104:107], v[136:139], v[32:47]
  ds_read_b64_tr_b16 v[100:101], v6 offset:18432
  ds_read_b64_tr_b16 v[102:103], v6 offset:18944
  v_mfma_f32_32x32x16_bf16 v[32:47], v[108:111], v[140:143], v[32:47]
  ds_read_b64_tr_b16 v[104:105], v6 offset:20480
  ds_read_b64_tr_b16 v[106:107], v6 offset:20992
  s_waitcnt lgkmcnt(10)
  v_mfma_f32_32x32x16_bf16 v[32:47], v[112:115], v[144:147], v[32:47]
  ds_read_b64_tr_b16 v[108:109], v6 offset:22528
  ds_read_b64_tr_b16 v[110:111], v6 offset:23040
  v_mfma_f32_32x32x16_bf16 v[32:47], v[116:119], v[148:151], v[32:47]
  ds_read_b64_tr_b16 v[112:113], v6 offset:24576
  ds_read_b64_tr_b16 v[114:115], v6 offset:25088
  s_waitcnt lgkmcnt(10)
  v_mfma_f32_32x32x16_bf16 v[32:47], v[120:123], v[152:155], v[32:47]
  ds_read_b64_tr_b16 v[116:117], v6 offset:26624
  ds_read_b64_tr_b16 v[118:119], v6 offset:27136
  v_mfma_f32_32x32x16_bf16 v[32:47], v[124:127], v[156:159], v[32:47]
  ds_read_b64_tr_b16 v[120:121], v6 offset:28672
  ds_read_b64_tr_b16 v[122:123], v6 offset:29184
  s_waitcnt lgkmcnt(10)
  v_mfma_f32_32x32x16_bf16 v[32:47], v[96:99], v[160:163], v[32:47]
  ds_read_b64_tr_b16 v[124:125], v6 offset:30720
  ds_read_b64_tr_b16 v[126:127], v6 offset:31232
  v_mfma_f32_32x32x16_bf16 v[32:47], v[100:103], v[164:167], v[32:47]
  s_waitcnt lgkmcnt(8)
  v_mfma_f32_32x32x16_bf16 v[32:47], v[104:107], v[168:171], v[32:47]
  v_mfma_f32_32x32x16_bf16 v[32:47], v[108:111], v[172:175], v[32:47]
  s_waitcnt vmcnt(0)
  buffer_store_dword v19, v20, s[60:63], s9 offen sc1
  s_waitcnt lgkmcnt(4)
  v_mfma_f32_32x32x16_bf16 v[32:47], v[112:115], v[176:179], v[32:47]
  s_waitcnt lgkmcnt(0)
  s_barrier
  ds_read_b64_tr_b16 v[96:97], v6 offset:32768
  ds_read_b64_tr_b16 v[98:99], v6 offset:33280
  ds_read_b64_tr_b16 v[100:101], v6 offset:34816
  ds_read_b64_tr_b16 v[102:103], v6 offset:35328
  ds_read_b64_tr_b16 v[104:105], v6 offset:36864
  ds_read_b64_tr_b16 v[106:107], v6 offset:37376
  ds_read_b64_tr_b16 v[108:109], v6 offset:38912
  ds_read_b64_tr_b16 v[110:111], v6 offset:39424
  v_mfma_f32_32x32x16_bf16 v[32:47], v[116:119], v[180:183], v[32:47]
  ds_read_b64_tr_b16 v[112:113], v6 offset:40960
  ds_read_b64_tr_b16 v[114:115], v6 offset:41472
  v_mfma_f32_32x32x16_bf16 v[32:47], v[120:123], v[184:187], v[32:47]
  ds_read_b64_tr_b16 v[116:117], v6 offset:43008
  ds_read_b64_tr_b16 v[118:119], v6 offset:43520
  v_mfma_f32_32x32x16_bf16 v[32:47], v[124:127], v[188:191], v[32:47]
  ds_read_b64_tr_b16 v[120:121], v6 offset:45056
  ds_read_b64_tr_b16 v[122:123], v6 offset:45568
  s_waitcnt lgkmcnt(10)
  v_mfma_f32_32x32x16_bf16 v[32:47], v[96:99], v[192:195], v[32:47]
  ds_read_b64_tr_b16 v[124:125], v6 offset:47104
  ds_read_b64_tr_b16 v[126:127], v6 offset:47616
  v_mfma_f32_32x32x16_bf16 v[32:47], v[100:103], v[196:199], v[32:47]
  ds_read_b64_tr_b16 v[96:97], v6 offset:49152
  ds_read_b64_tr_b16 v[98:99], v6 offset:49664
  s_waitcnt lgkmcnt(10)
  v_mfma_f32_32x32x16_bf16 v[32:47], v[104:107], v[200:203], v[32:47]
  ds_read_b64_tr_b16 v[100:101], v6 offset:51200
  ds_read_b64_tr_b16 v[102:103], v6 offset:51712
  v_mfma_f32_32x32x16_bf16 v[32:47], v[108:111], v[204:207], v[32:47]
  ds_read_b64_tr_b16 v[104:105], v6 offset:53248
  ds_read_b64_tr_b16 v[106:107], v6 offset:53760
  s_waitcnt lgkmcnt(10)
  v_mfma_f32_32x32x16_bf16 v[32:47], v[112:115], v[208:211], v[32:47]
  ds_read_b64_tr_b16 v[108:109], v6 offset:55296
  ds_read_b64_tr_b16 v[110:111], v6 offset:55808
  v_mfma_f32_32x32x16_bf16 v[32:47], v[116:119], v[212:215], v[32:47]
  ds_read_b64_tr_b16 v[112:113], v6 offset:57344
  ds_read_b64_tr_b16 v[114:115], v6 offset:57856
  s_waitcnt lgkmcnt(10)
  v_mfma_f32_32x32x16_bf16 v[32:47], v[120:123], v[216:219], v[32:47]
  ds_read_b64_tr_b16 v[116:117], v6 offset:59392
  ds_read_b64_tr_b16 v[118:119], v6 offset:59904
  v_mfma_f32_32x32x16_bf16 v[32:47], v[124:127], v[220:223], v[32:47]
  ds_read_b64_tr_b16 v[120:121], v6 offset:61440
  ds_read_b64_tr_b16 v[122:123], v6 offset:61952
  s_waitcnt lgkmcnt(10)
  v_mfma_f32_32x32x16_bf16 v[32:47], v[96:99], v[224:227], v[32:47]
  ds_read_b64_tr_b16 v[124:125], v6 offset:63488
  ds_read_b64_tr_b16 v[126:127], v6 offset:64000
  v_mfma_f32_32x32x16_bf16 v[32:47], v[100:103], v[228:231], v[32:47]
  s_waitcnt lgkmcnt(8)
  v_mfma_f32_32x32x16_bf16 v[32:47], v[104:107], v[232:235], v[32:47]
  v_mfma_f32_32x32x16_bf16 v[32:47], v[108:111], v[236:239], v[32:47]
  s_waitcnt lgkmcnt(4)
  v_mfma_f32_32x32x16_bf16 v[32:47], v[112:115], v[240:243], v[32:47]
  v_mfma_f32_32x32x16_bf16 v[32:47], v[116:119], v[244:247], v[32:47]
  s_waitcnt lgkmcnt(0)
  v_mfma_f32_32x32x16_bf16 v[32:47], v[120:123], v[248:251], v[32:47]
  v_mfma_f32_32x32x16_bf16 v[32:47], v[124:127], v[252:255], v[32:47]
  s_barrier
  s_nop 10
  v_mul_f32 v112, 0x3fb8aa3b, v32
  v_mul_f32 v113, 0x3fb8aa3b, v33
  v_mul_f32 v114, 0x3fb8aa3b, v34
  v_mul_f32 v115, 0x3fb8aa3b, v35
  v_mul_f32 v116, 0x3fb8aa3b, v36
  v_mul_f32 v117, 0x3fb8aa3b, v37
  v_mul_f32 v118, 0x3fb8aa3b, v38
  v_mul_f32 v119, 0x3fb8aa3b, v39
  v_mul_f32 v120, 0x3fb8aa3b, v40
  v_mul_f32 v121, 0x3fb8aa3b, v41
  v_mul_f32 v122, 0x3fb8aa3b, v42
  v_mul_f32 v123, 0x3fb8aa3b, v43
  v_mul_f32 v124, 0x3fb8aa3b, v44
  v_mul_f32 v125, 0x3fb8aa3b, v45
  v_mul_f32 v126, 0x3fb8aa3b, v46
  v_mul_f32 v127, 0x3fb8aa3b, v47
  v_add_f32 v96, s13, v32
  v_add_f32 v97, s13, v33
  v_add_f32 v98, s13, v34
  v_add_f32 v99, s13, v35
  v_add_f32 v100, s13, v36
  v_add_f32 v101, s13, v37
  v_add_f32 v102, s13, v38
  v_add_f32 v103, s13, v39
  v_add_f32 v104, s13, v40
  v_add_f32 v105, s13, v41
  v_add_f32 v106, s13, v42
  v_add_f32 v107, s13, v43
  v_add_f32 v108, s13, v44
  v_add_f32 v109, s13, v45
  v_add_f32 v110, s13, v46
  v_add_f32 v111, s13, v47
  v_exp_f32 v112, v112 clamp
  v_exp_f32 v113, v113 clamp
  v_exp_f32 v114, v114 clamp
  v_exp_f32 v115, v115 clamp
  v_exp_f32 v116, v116 clamp
  v_exp_f32 v117, v117 clamp
  v_exp_f32 v118, v118 clamp
  v_exp_f32 v119, v119 clamp
  v_exp_f32 v120, v120 clamp
  v_exp_f32 v121, v121 clamp
  v_exp_f32 v122, v122 clamp
  v_exp_f32 v123, v123 clamp
  v_exp_f32 v124, v124 clamp
  v_exp_f32 v125, v125 clamp
  v_exp_f32 v126, v126 clamp
  v_exp_f32 v127, v127 clamp
  v_max_f32 v96, s13, v96
  v_max_f32 v97, s13, v97
  v_max_f32 v98, s13, v98
  v_max_f32 v99, s13, v99
  v_max_f32 v100, s13, v100
  v_max_f32 v101, s13, v101
  v_max_f32 v102, s13, v102
  v_max_f32 v103, s13, v103
  v_max_f32 v104, s13, v104
  v_max_f32 v105, s13, v105
  v_max_f32 v106, s13, v106
  v_max_f32 v107, s13, v107
  v_max_f32 v108, s13, v108
  v_max_f32 v109, s13, v109
  v_max_f32 v110, s13, v110
  v_max_f32 v111, s13, v111
  v_add_f32 v96, v96, v112
  v_add_f32 v97, v97, v113
  v_add_f32 v98, v98, v114
  v_add_f32 v99, v99, v115
  v_add_f32 v100, v100, v116
  v_add_f32 v101, v101, v117
  v_add_f32 v102, v102, v118
  v_add_f32 v103, v103, v119
  v_add_f32 v104, v104, v120
  v_add_f32 v105, v105, v121
  v_add_f32 v106, v106, v122
  v_add_f32 v107, v107, v123
  v_add_f32 v108, v108, v124
  v_add_f32 v109, v109, v125
  v_add_f32 v110, v110, v126
  v_add_f32 v111, v111, v127
  v_cvt_pk_bf16_f32 v64, v96, v97
  v_cvt_pk_bf16_f32 v65, v98, v99
  v_cvt_pk_bf16_f32 v66, v100, v101
  v_cvt_pk_bf16_f32 v67, v102, v103
  v_cvt_pk_bf16_f32 v68, v104, v105
  v_cvt_pk_bf16_f32 v69, v106, v107
  v_cvt_pk_bf16_f32 v70, v108, v109
  v_cvt_pk_bf16_f32 v71, v110, v111
  ds_write_b128 v17, v[64:67]
  ds_write_b128 v17, v[68:71] offset:1024
  s_lshl_b32 s10, s4, 5
  s_add_u32 s10, s10, 0x1709000
  s_lshl_b32 s11, s4, 10
  s_add_u32 s11, s11, 0x1400000
  s_mul_i32 s72, s6, 114688
  s_lshl_b32 s73, s28, 14
  s_add_u32 s72, s72, s73
  s_lshl_b32 s73, s31, 11
  s_add_u32 s72, s72, s73
  s_add_u32 s14, s72, 0xa00000
  s_cmp_eq_u32 s28, 7
  s_cselect_b32 s72, 0x7f000000, 0
  v_or_b32 v4, s72, v21
  s_barrier
  ds_read_b64_tr_b16 v[96:97], v8 offset:0
  ds_read_b64_tr_b16 v[98:99], v8 offset:1024
  ds_read_b128 v[128:131], v16 offset:0
  ds_read_b128 v[132:135], v16 offset:1024
  ds_read_b128 v[136:139], v16 offset:2048
  ds_read_b128 v[140:143], v16 offset:3072
  ds_read_b64_tr_b16 v[100:101], v8 offset:2048
  ds_read_b64_tr_b16 v[102:103], v8 offset:3072
  ds_read_b128 v[144:147], v16 offset:4096
  ds_read_b128 v[148:151], v16 offset:5120
  ds_read_b128 v[152:155], v16 offset:6144
  ds_read_b128 v[156:159], v16 offset:7168
  ds_read_b64_tr_b16 v[104:105], v8 offset:4096
  s_waitcnt lgkmcnt(14)
  ds_read_b64_tr_b16 v[106:107], v8 offset:5120
  s_waitcnt lgkmcnt(14)
  ds_read_b128 v[160:163], v16 offset:8192
  s_waitcnt lgkmcnt(14)
  ds_read_b128 v[164:167], v16 offset:9216
  s_waitcnt lgkmcnt(14)
  ds_read_b128 v[168:171], v16 offset:10240
  s_waitcnt lgkmcnt(14)
  ds_read_b128 v[172:175], v16 offset:11264
  s_waitcnt lgkmcnt(14)
  ds_read_b64_tr_b16 v[108:109], v8 offset:6144
  s_waitcnt lgkmcnt(14)
  ds_read_b64_tr_b16 v[110:111], v8 offset:7168
  s_waitcnt lgkmcnt(14)
  ds_read_b128 v[176:179], v16 offset:12288
  s_waitcnt lgkmcnt(14)
  ds_read_b128 v[180:183], v16 offset:13312
  s_waitcnt lgkmcnt(14)
  ds_read_b128 v[184:187], v16 offset:14336
  s_waitcnt lgkmcnt(14)
  ds_read_b128 v[188:191], v16 offset:15360
  v_mfma_f32_32x32x16_bf16 v[32:47], v[96:99], v[128:131], 0
  s_waitcnt lgkmcnt(14)
  ds_read_b64_tr_b16 v[112:113], v8 offset:8192
  s_waitcnt lgkmcnt(14)
  ds_read_b64_tr_b16 v[114:115], v8 offset:9216
  v_mfma_f32_32x32x16_bf16 v[32:47], v[100:103], v[132:135], v[32:47]
  s_waitcnt lgkmcnt(2)
  s_barrier
  ds_read_b64_tr_b16 v[116:117], v8 offset:10240
  ds_read_b64_tr_b16 v[118:119], v8 offset:11264
  v_mfma_f32_32x32x16_bf16 v[32:47], v[104:107], v[136:139], v[32:47]
  ds_read_b64_tr_b16 v[120:121], v8 offset:12288
  ds_read_b64_tr_b16 v[122:123], v8 offset:13312
  v_mfma_f32_32x32x16_bf16 v[32:47], v[108:111], v[140:143], v[32:47]
  ds_read_b64_tr_b16 v[124:125], v8 offset:14336
  ds_read_b64_tr_b16 v[126:127], v8 offset:15360
  s_waitcnt lgkmcnt(6)
  v_mfma_f32_32x32x16_bf16 v[32:47], v[112:115], v[144:147], v[32:47]
  ds_read_b64_tr_b16 v[96:97], v8 offset:16384
  ds_read_b64_tr_b16 v[98:99], v8 offset:17408
  s_waitcnt lgkmcnt(6)
  v_mfma_f32_32x32x16_bf16 v[32:47], v[116:119], v[148:151], v[32:47]
  ds_read_b64_tr_b16 v[100:101], v8 offset:18432
  ds_read_b64_tr_b16 v[102:103], v8 offset:19456
  s_waitcnt lgkmcnt(6)
  v_mfma_f32_32x32x16_bf16 v[32:47], v[120:123], v[152:155], v[32:47]
  ds_read_b64_tr_b16 v[104:105], v8 offset:20480
  ds_read_b64_tr_b16 v[106:107], v8 offset:21504
  s_waitcnt lgkmcnt(6)
  v_mfma_f32_32x32x16_bf16 v[32:47], v[124:127], v[156:159], v[32:47]
  ds_read_b64_tr_b16 v[108:109], v8 offset:22528
  ds_read_b64_tr_b16 v[110:111], v8 offset:23552
  s_waitcnt lgkmcnt(6)
  v_mfma_f32_32x32x16_bf16 v[32:47], v[96:99], v[160:163], v[32:47]
  ds_read_b64_tr_b16 v[112:113], v8 offset:24576
  ds_read_b64_tr_b16 v[114:115], v8 offset:25600
  s_waitcnt lgkmcnt(6)
  v_mfma_f32_32x32x16_bf16 v[32:47], v[100:103], v[164:167], v[32:47]
  s_barrier
  ds_read_b64_tr_b16 v[116:117], v8 offset:26624
  ds_read_b64_tr_b16 v[118:119], v8 offset:27648
  ds_read_b128 v[192:195], v16 offset:32768
  ds_read_b128 v[196:199], v16 offset:33792
  ds_read_b128 v[200:203], v16 offset:34816
  ds_read_b128 v[204:207], v16 offset:35840
  s_waitcnt lgkmcnt(10)
  v_mfma_f32_32x32x16_bf16 v[32:47], v[104:107], v[168:171], v[32:47]
  ds_read_b64_tr_b16 v[120:121], v8 offset:28672
  ds_read_b64_tr_b16 v[122:123], v8 offset:29696
  ds_read_b128 v[208:211], v16 offset:36864
  ds_read_b128 v[212:215], v16 offset:37888
  ds_read_b128 v[216:219], v16 offset:38912
  s_waitcnt lgkmcnt(14)
  ds_read_b128 v[220:223], v16 offset:39936
  s_waitcnt lgkmcnt(14)
  v_mfma_f32_32x32x16_bf16 v[32:47], v[108:111], v[172:175], v[32:47]
  ds_read_b64_tr_b16 v[124:125], v8 offset:30720
  s_waitcnt lgkmcnt(14)
  ds_read_b64_tr_b16 v[126:127], v8 offset:31744
  s_waitcnt lgkmcnt(14)
  ds_read_b128 v[224:227], v16 offset:40960
  s_waitcnt lgkmcnt(14)
  ds_read_b128 v[228:231], v16 offset:41984
  s_waitcnt lgkmcnt(14)
  ds_read_b128 v[232:235], v16 offset:43008
  s_waitcnt lgkmcnt(14)
  ds_read_b128 v[236:239], v16 offset:44032
  v_mfma_f32_32x32x16_bf16 v[32:47], v[112:115], v[176:179], v[32:47]
  s_waitcnt lgkmcnt(4)
  s_barrier
  ds_read_b64_tr_b16 v[96:97], v8 offset:32768
  ds_read_b64_tr_b16 v[98:99], v8 offset:33792
  ds_read_b64_tr_b16 v[100:101], v8 offset:34816
  ds_read_b64_tr_b16 v[102:103], v8 offset:35840
  ds_read_b64_tr_b16 v[104:105], v8 offset:36864
  ds_read_b64_tr_b16 v[106:107], v8 offset:37888
  ds_read_b64_tr_b16 v[108:109], v8 offset:38912
  ds_read_b64_tr_b16 v[110:111], v8 offset:39936
  ds_read_b128 v[240:243], v16 offset:45056
  ds_read_b128 v[244:247], v16 offset:46080
  ds_read_b128 v[248:251], v16 offset:47104
  s_waitcnt lgkmcnt(14)
  ds_read_b128 v[252:255], v16 offset:48128
  v_mfma_f32_32x32x16_bf16 v[32:47], v[116:119], v[180:183], v[32:47]
  s_waitcnt lgkmcnt(14)
  ds_read_b64_tr_b16 v[112:113], v8 offset:40960
  s_waitcnt lgkmcnt(14)
  ds_read_b64_tr_b16 v[114:115], v8 offset:41984
  v_mfma_f32_32x32x16_bf16 v[32:47], v[120:123], v[184:187], v[32:47]
  s_waitcnt lgkmcnt(2)
  s_barrier
  ds_read_b64_tr_b16 v[116:117], v8 offset:43008
  ds_read_b64_tr_b16 v[118:119], v8 offset:44032
  v_mfma_f32_32x32x16_bf16 v[32:47], v[124:127], v[188:191], v[32:47]
  ds_read_b64_tr_b16 v[120:121], v8 offset:45056
  ds_read_b64_tr_b16 v[122:123], v8 offset:46080
  v_mfma_f32_32x32x16_bf16 v[32:47], v[96:99], v[192:195], v[32:47]
  ds_read_b64_tr_b16 v[124:125], v8 offset:47104
  ds_read_b64_tr_b16 v[126:127], v8 offset:48128
  v_mfma_f32_32x32x16_bf16 v[32:47], v[100:103], v[196:199], v[32:47]
  ds_read_b64_tr_b16 v[96:97], v8 offset:49152
  ds_read_b64_tr_b16 v[98:99], v8 offset:50176
  v_mfma_f32_32x32x16_bf16 v[32:47], v[104:107], v[200:203], v[32:47]
  ds_read_b64_tr_b16 v[100:101], v8 offset:51200
  ds_read_b64_tr_b16 v[102:103], v8 offset:52224
  v_mfma_f32_32x32x16_bf16 v[32:47], v[108:111], v[204:207], v[32:47]
  ds_read_b64_tr_b16 v[104:105], v8 offset:53248
  ds_read_b64_tr_b16 v[106:107], v8 offset:54272
  s_waitcnt lgkmcnt(10)
  v_mfma_f32_32x32x16_bf16 v[32:47], v[112:115], v[208:211], v[32:47]
  ds_read_b64_tr_b16 v[108:109], v8 offset:55296
  ds_read_b64_tr_b16 v[110:111], v8 offset:56320
  v_mfma_f32_32x32x16_bf16 v[32:47], v[116:119], v[212:215], v[32:47]
  ds_read_b64_tr_b16 v[112:113], v8 offset:57344
  ds_read_b64_tr_b16 v[114:115], v8 offset:58368
  s_waitcnt lgkmcnt(10)
  v_mfma_f32_32x32x16_bf16 v[32:47], v[120:123], v[216:219], v[32:47]
  ds_read_b64_tr_b16 v[116:117], v8 offset:59392
  ds_read_b64_tr_b16 v[118:119], v8 offset:60416
  v_mfma_f32_32x32x16_bf16 v[32:47], v[124:127], v[220:223], v[32:47]
  ds_read_b64_tr_b16 v[120:121], v8 offset:61440
  ds_read_b64_tr_b16 v[122:123], v8 offset:62464
  s_waitcnt lgkmcnt(10)
  v_mfma_f32_32x32x16_bf16 v[32:47], v[96:99], v[224:227], v[32:47]
  ds_read_b64_tr_b16 v[124:125], v8 offset:63488
  ds_read_b64_tr_b16 v[126:127], v8 offset:64512
  v_mfma_f32_32x32x16_bf16 v[32:47], v[100:103], v[228:231], v[32:47]
  s_waitcnt lgkmcnt(8)
  v_mfma_f32_32x32x16_bf16 v[32:47], v[104:107], v[232:235], v[32:47]
  v_mfma_f32_32x32x16_bf16 v[32:47], v[108:111], v[236:239], v[32:47]
  s_waitcnt lgkmcnt(4)
  v_mfma_f32_32x32x16_bf16 v[32:47], v[112:115], v[240:243], v[32:47]
  s_waitcnt lgkmcnt(0)
  s_barrier
  ds_read_b64_tr_b16 v[96:97], v9 offset:0
  ds_read_b64_tr_b16 v[98:99], v9 offset:1024
  ds_read_b64_tr_b16 v[100:101], v9 offset:2048
  ds_read_b64_tr_b16 v[102:103], v9 offset:3072
  ds_read_b64_tr_b16 v[104:105], v9 offset:4096
  ds_read_b64_tr_b16 v[106:107], v9 offset:5120
  ds_read_b64_tr_b16 v[108:109], v9 offset:6144
  ds_read_b64_tr_b16 v[110:111], v9 offset:7168
  v_mfma_f32_32x32x16_bf16 v[32:47], v[116:119], v[244:247], v[32:47]
  ds_read_b64_tr_b16 v[112:113], v9 offset:8192
  ds_read_b64_tr_b16 v[114:115], v9 offset:9216
  v_mfma_f32_32x32x16_bf16 v[32:47], v[120:123], v[248:251], v[32:47]
  s_lshl_b32 s72, s30, 9
  s_add_u32 s72, s72, 157696
  v_lshl_add_u32 v31, v1, 4, s72
  ds_read_b128 v[12:15], v31
  s_lshl_b32 s72, s31, 7
  s_add_u32 s72, s72, 156672
  v_lshl_add_u32 v16, v2, 4, s72
  ds_read_b128 v[64:67], v16 offset:0
  ds_read_b128 v[68:71], v16 offset:32
  ds_read_b128 v[72:75], v16 offset:64
  ds_read_b128 v[76:79], v16 offset:96
  s_waitcnt lgkmcnt(14)
  ds_read_b64_tr_b16 v[116:117], v9 offset:10240
  s_waitcnt lgkmcnt(14)
  ds_read_b64_tr_b16 v[118:119], v9 offset:11264
  v_mfma_f32_32x32x16_bf16 v[48:63], v[124:127], v[252:255], v[32:47]
  s_waitcnt lgkmcnt(14)
  ds_read_b64_tr_b16 v[120:121], v9 offset:12288
  s_waitcnt lgkmcnt(14)
  ds_read_b64_tr_b16 v[122:123], v9 offset:13312
  v_mfma_f32_32x32x16_bf16 v[32:47], v[96:99], v[128:131], 0
  s_waitcnt lgkmcnt(14)
  ds_read_b64_tr_b16 v[124:125], v9 offset:14336
  s_waitcnt lgkmcnt(14)
  ds_read_b64_tr_b16 v[126:127], v9 offset:15360
  v_mfma_f32_32x32x16_bf16 v[32:47], v[100:103], v[132:135], v[32:47]
  s_add_u32 s15, s14, 0
  s_waitcnt lgkmcnt(6)
  v_fma_f32 v48, -v12, v64, v48
  v_fma_f32 v49, -v12, v65, v49
  v_fma_f32 v50, -v12, v66, v50
  v_fma_f32 v51, -v12, v67, v51
  v_fma_f32 v52, -v12, v68, v52
  v_fma_f32 v53, -v12, v69, v53
  v_fma_f32 v54, -v12, v70, v54
  v_fma_f32 v55, -v12, v71, v55
  ds_read_b64_tr_b16 v[96:97], v9 offset:16384
  ds_read_b64_tr_b16 v[98:99], v9 offset:17408
  v_mfma_f32_32x32x16_bf16 v[32:47], v[104:107], v[136:139], v[32:47]
  v_mul_f32 v80, v48, v48
  v_mul_f32 v81, v49, v49
  v_mul_f32 v82, v50, v50
  v_mul_f32 v83, v51, v51
  v_mul_f32 v84, v52, v52
  v_mul_f32 v85, v53, v53
  v_mul_f32 v86, v54, v54
  v_mul_f32 v87, v55, v55
  v_fma_f32 v80, v80, v14, v13
  ds_read_b64_tr_b16 v[100:101], v9 offset:18432
  ds_read_b64_tr_b16 v[102:103], v9 offset:19456
  v_mfma_f32_32x32x16_bf16 v[32:47], v[108:111], v[140:143], v[32:47]
  v_fma_f32 v81, v81, v14, v13
  v_fma_f32 v82, v82, v14, v13
  v_fma_f32 v83, v83, v14, v13
  v_fma_f32 v84, v84, v14, v13
  v_fma_f32 v85, v85, v14, v13
  v_fma_f32 v86, v86, v14, v13
  v_fma_f32 v87, v87, v14, v13
  v_mul_f32 v80, v80, v48
  v_mul_f32 v81, v81, v49
  ds_read_b64_tr_b16 v[104:105], v9 offset:20480
  ds_read_b64_tr_b16 v[106:107], v9 offset:21504
  v_mfma_f32_32x32x16_bf16 v[32:47], v[112:115], v[144:147], v[32:47]
  v_mul_f32 v82, v82, v50
  v_mul_f32 v83, v83, v51
  v_mul_f32 v84, v84, v52
  v_mul_f32 v85, v85, v53
  v_mul_f32 v86, v86, v54
  v_mul_f32 v87, v87, v55
  v_exp_f32 v80, v80
  v_exp_f32 v81, v81
  ds_read_b64_tr_b16 v[108:109], v9 offset:22528
  ds_read_b64_tr_b16 v[110:111], v9 offset:23552
  s_waitcnt lgkmcnt(10)
  v_mfma_f32_32x32x16_bf16 v[32:47], v[116:119], v[148:151], v[32:47]
  v_exp_f32 v82, v82
  v_exp_f32 v83, v83
  v_exp_f32 v84, v84
  v_exp_f32 v85, v85
  ds_read_b64_tr_b16 v[112:113], v9 offset:24576
  ds_read_b64_tr_b16 v[114:115], v9 offset:25600
  v_mfma_f32_32x32x16_bf16 v[32:47], v[120:123], v[152:155], v[32:47]
  v_exp_f32 v86, v86
  v_exp_f32 v87, v87
  v_fma_f32 v80, v80, v15, v15
  v_fma_f32 v81, v81, v15, v15
  v_fma_f32 v82, v82, v15, v15
  v_fma_f32 v83, v83, v15, v15
  v_fma_f32 v84, v84, v15, v15
  v_fma_f32 v85, v85, v15, v15
  ds_read_b64_tr_b16 v[116:117], v9 offset:26624
  ds_read_b64_tr_b16 v[118:119], v9 offset:27648
  s_waitcnt lgkmcnt(10)
  v_mfma_f32_32x32x16_bf16 v[32:47], v[124:127], v[156:159], v[32:47]
  v_fma_f32 v86, v86, v15, v15
  v_fma_f32 v87, v87, v15, v15
  v_rcp_f32 v80, v80
  v_rcp_f32 v81, v81
  v_rcp_f32 v82, v82
  ds_read_b64_tr_b16 v[120:121], v9 offset:28672
  ds_read_b64_tr_b16 v[122:123], v9 offset:29696
  v_mfma_f32_32x32x16_bf16 v[32:47], v[96:99], v[160:163], v[32:47]
  v_rcp_f32 v83, v83
  v_rcp_f32 v84, v84
  v_rcp_f32 v85, v85
  v_rcp_f32 v86, v86
  v_rcp_f32 v87, v87
  ds_read_b64_tr_b16 v[124:125], v9 offset:30720
  ds_read_b64_tr_b16 v[126:127], v9 offset:31744
  s_waitcnt lgkmcnt(10)
  v_mfma_f32_32x32x16_bf16 v[32:47], v[100:103], v[164:167], v[32:47]
  v_mul_f32 v48, v48, v80
  v_mul_f32 v49, v49, v81
  v_mul_f32 v50, v50, v82
  v_mul_f32 v51, v51, v83
  v_mul_f32 v52, v52, v84
  v_mul_f32 v53, v53, v85
  v_mul_f32 v54, v54, v86
  v_mul_f32 v55, v55, v87
  v_cvt_pk_bf16_f32 v88, v48, v49
  v_mfma_f32_32x32x16_bf16 v[32:47], v[104:107], v[168:171], v[32:47]
  v_cvt_pk_bf16_f32 v89, v50, v51
  v_cvt_pk_bf16_f32 v90, v52, v53
  v_cvt_pk_bf16_f32 v91, v54, v55
  buffer_store_dwordx4 v[88:91], v4, s[60:63], s15 offen sc1
  v_fma_f32 v56, -v12, v72, v56
  v_fma_f32 v57, -v12, v73, v57
  v_fma_f32 v58, -v12, v74, v58
  v_fma_f32 v59, -v12, v75, v59
  s_waitcnt lgkmcnt(6)
  v_mfma_f32_32x32x16_bf16 v[32:47], v[108:111], v[172:175], v[32:47]
  v_fma_f32 v60, -v12, v76, v60
  v_fma_f32 v61, -v12, v77, v61
  v_fma_f32 v62, -v12, v78, v62
  v_fma_f32 v63, -v12, v79, v63
  v_mul_f32 v80, v56, v56
  v_mul_f32 v81, v57, v57
  v_mul_f32 v82, v58, v58
  v_mul_f32 v83, v59, v59
  v_mul_f32 v84, v60, v60
  v_mfma_f32_32x32x16_bf16 v[32:47], v[112:115], v[176:179], v[32:47]
  v_mul_f32 v85, v61, v61
  v_mul_f32 v86, v62, v62
  v_mul_f32 v87, v63, v63
  v_fma_f32 v80, v80, v14, v13
  v_fma_f32 v81, v81, v14, v13
  v_fma_f32 v82, v82, v14, v13
  v_fma_f32 v83, v83, v14, v13
  v_fma_f32 v84, v84, v14, v13
  v_fma_f32 v85, v85, v14, v13
  s_waitcnt lgkmcnt(0)
  s_barrier
  ds_read_b64_tr_b16 v[96:97], v9 offset:32768
  ds_read_b64_tr_b16 v[98:99], v9 offset:33792
  ds_read_b64_tr_b16 v[100:101], v9 offset:34816
  ds_read_b64_tr_b16 v[102:103], v9 offset:35840
  ds_read_b64_tr_b16 v[104:105], v9 offset:36864
  ds_read_b64_tr_b16 v[106:107], v9 offset:37888
  ds_read_b64_tr_b16 v[108:109], v9 offset:38912
  ds_read_b64_tr_b16 v[110:111], v9 offset:39936
  v_mfma_f32_32x32x16_bf16 v[32:47], v[116:119], v[180:183], v[32:47]
  v_fma_f32 v86, v86, v14, v13
  v_fma_f32 v87, v87, v14, v13
  v_mul_f32 v80, v80, v56
  v_mul_f32 v81, v81, v57
  v_mul_f32 v82, v82, v58
  v_mul_f32 v83, v83, v59
  v_mul_f32 v84, v84, v60
  v_mul_f32 v85, v85, v61
  v_mul_f32 v86, v86, v62
  ds_read_b64_tr_b16 v[112:113], v9 offset:40960
  ds_read_b64_tr_b16 v[114:115], v9 offset:41984
  v_mfma_f32_32x32x16_bf16 v[32:47], v[120:123], v[184:187], v[32:47]
  v_mul_f32 v87, v87, v63
  v_exp_f32 v80, v80
  v_exp_f32 v81, v81
  v_exp_f32 v82, v82
  v_exp_f32 v83, v83
  ds_read_b64_tr_b16 v[116:117], v9 offset:43008
  ds_read_b64_tr_b16 v[118:119], v9 offset:44032
  v_mfma_f32_32x32x16_bf16 v[32:47], v[124:127], v[188:191], v[32:47]
  v_exp_f32 v84, v84
  v_exp_f32 v85, v85
  v_exp_f32 v86, v86
  v_exp_f32 v87, v87
  v_fma_f32 v80, v80, v15, v15
  v_fma_f32 v81, v81, v15, v15
  ds_read_b64_tr_b16 v[120:121], v9 offset:45056
  ds_read_b64_tr_b16 v[122:123], v9 offset:46080
  s_waitcnt lgkmcnt(10)
  v_mfma_f32_32x32x16_bf16 v[32:47], v[96:99], v[192:195], v[32:47]
  v_fma_f32 v82, v82, v15, v15
  v_fma_f32 v83, v83, v15, v15
  v_fma_f32 v84, v84, v15, v15
  v_fma_f32 v85, v85, v15, v15
  v_fma_f32 v86, v86, v15, v15
  v_fma_f32 v87, v87, v15, v15
  v_rcp_f32 v80, v80
  ds_read_b64_tr_b16 v[124:125], v9 offset:47104
  ds_read_b64_tr_b16 v[126:127], v9 offset:48128
  v_mfma_f32_32x32x16_bf16 v[32:47], v[100:103], v[196:199], v[32:47]
  v_rcp_f32 v81, v81
  v_rcp_f32 v82, v82
  v_rcp_f32 v83, v83
  v_rcp_f32 v84, v84
  v_rcp_f32 v85, v85
  ds_read_b64_tr_b16 v[96:97], v9 offset:49152
  ds_read_b64_tr_b16 v[98:99], v9 offset:50176
  s_waitcnt lgkmcnt(10)
  v_mfma_f32_32x32x16_bf16 v[32:47], v[104:107], v[200:203], v[32:47]
  v_rcp_f32 v86, v86
  v_rcp_f32 v87, v87
  v_mul_f32 v56, v56, v80
  v_mul_f32 v57, v57, v81
  v_mul_f32 v58, v58, v82
  v_mul_f32 v59, v59, v83
  v_mul_f32 v60, v60, v84
  ds_read_b64_tr_b16 v[100:101], v9 offset:51200
  ds_read_b64_tr_b16 v[102:103], v9 offset:52224
  v_mfma_f32_32x32x16_bf16 v[32:47], v[108:111], v[204:207], v[32:47]
  v_mul_f32 v61, v61, v85
  v_mul_f32 v62, v62, v86
  v_mul_f32 v63, v63, v87
  v_cvt_pk_bf16_f32 v92, v56, v57
  v_cvt_pk_bf16_f32 v93, v58, v59
  v_cvt_pk_bf16_f32 v94, v60, v61
  v_cvt_pk_bf16_f32 v95, v62, v63
  buffer_store_dwordx4 v[92:95], v4, s[60:63], s15 offen offset:1024 sc1
  ds_read_b64_tr_b16 v[104:105], v9 offset:53248
  ds_read_b64_tr_b16 v[106:107], v9 offset:54272
  s_waitcnt lgkmcnt(10)
  v_mfma_f32_32x32x16_bf16 v[32:47], v[112:115], v[208:211], v[32:47]
  ds_read_b64_tr_b16 v[108:109], v9 offset:55296
  ds_read_b64_tr_b16 v[110:111], v9 offset:56320
  v_mfma_f32_32x32x16_bf16 v[32:47], v[116:119], v[212:215], v[32:47]
  ds_read_b64_tr_b16 v[112:113], v9 offset:57344
  ds_read_b64_tr_b16 v[114:115], v9 offset:58368
  s_waitcnt lgkmcnt(10)
  v_mfma_f32_32x32x16_bf16 v[32:47], v[120:123], v[216:219], v[32:47]
  ds_read_b64_tr_b16 v[116:117], v9 offset:59392
  ds_read_b64_tr_b16 v[118:119], v9 offset:60416
  v_mfma_f32_32x32x16_bf16 v[32:47], v[124:127], v[220:223], v[32:47]
  ds_read_b64_tr_b16 v[120:121], v9 offset:61440
  ds_read_b64_tr_b16 v[122:123], v9 offset:62464
  s_waitcnt lgkmcnt(10)
  v_mfma_f32_32x32x16_bf16 v[32:47], v[96:99], v[224:227], v[32:47]
  ds_read_b64_tr_b16 v[124:125], v9 offset:63488
  ds_read_b64_tr_b16 v[126:127], v9 offset:64512
  v_mfma_f32_32x32x16_bf16 v[32:47], v[100:103], v[228:231], v[32:47]
  s_waitcnt lgkmcnt(8)
  v_mfma_f32_32x32x16_bf16 v[32:47], v[104:107], v[232:235], v[32:47]
  v_mfma_f32_32x32x16_bf16 v[32:47], v[108:111], v[236:239], v[32:47]
  s_waitcnt lgkmcnt(4)
  v_mfma_f32_32x32x16_bf16 v[32:47], v[112:115], v[240:243], v[32:47]
  s_waitcnt lgkmcnt(0)
  s_barrier
  ds_read_b64_tr_b16 v[96:97], v8 offset:0
  ds_read_b64_tr_b16 v[98:99], v8 offset:1024
  ds_read_b64_tr_b16 v[100:101], v8 offset:2048
  ds_read_b64_tr_b16 v[102:103], v8 offset:3072
  ds_read_b64_tr_b16 v[104:105], v8 offset:4096
  ds_read_b64_tr_b16 v[106:107], v8 offset:5120
  ds_read_b64_tr_b16 v[108:109], v8 offset:6144
  ds_read_b64_tr_b16 v[110:111], v8 offset:7168
  v_mfma_f32_32x32x16_bf16 v[32:47], v[116:119], v[244:247], v[32:47]
  ds_read_b64_tr_b16 v[112:113], v8 offset:8192
  ds_read_b64_tr_b16 v[114:115], v8 offset:9216
  v_mfma_f32_32x32x16_bf16 v[32:47], v[120:123], v[248:251], v[32:47]
  ds_read_b128 v[64:67], v16 offset:256
  ds_read_b128 v[68:71], v16 offset:288
  ds_read_b128 v[72:75], v16 offset:320
  ds_read_b128 v[76:79], v16 offset:352
  ds_read_b64_tr_b16 v[116:117], v8 offset:10240
  s_waitcnt lgkmcnt(14)
  ds_read_b64_tr_b16 v[118:119], v8 offset:11264
  v_mfma_f32_32x32x16_bf16 v[48:63], v[124:127], v[252:255], v[32:47]
  s_waitcnt lgkmcnt(14)
  ds_read_b64_tr_b16 v[120:121], v8 offset:12288
  s_waitcnt lgkmcnt(14)
  ds_read_b64_tr_b16 v[122:123], v8 offset:13312
  v_mfma_f32_32x32x16_bf16 v[32:47], v[96:99], v[128:131], 0
  s_waitcnt lgkmcnt(14)
  ds_read_b64_tr_b16 v[124:125], v8 offset:14336
  s_waitcnt lgkmcnt(14)
  ds_read_b64_tr_b16 v[126:127], v8 offset:15360
  v_mfma_f32_32x32x16_bf16 v[32:47], v[100:103], v[132:135], v[32:47]
  s_add_u32 s15, s14, 4096
  s_waitcnt lgkmcnt(6)
  v_fma_f32 v48, -v12, v64, v48
  v_fma_f32 v49, -v12, v65, v49
  v_fma_f32 v50, -v12, v66, v50
  v_fma_f32 v51, -v12, v67, v51
  v_fma_f32 v52, -v12, v68, v52
  ds_read_b64_tr_b16 v[96:97], v8 offset:16384
  ds_read_b64_tr_b16 v[98:99], v8 offset:17408
  v_mfma_f32_32x32x16_bf16 v[32:47], v[104:107], v[136:139], v[32:47]
  v_fma_f32 v53, -v12, v69, v53
  v_fma_f32 v54, -v12, v70, v54
  v_fma_f32 v55, -v12, v71, v55
  v_mul_f32 v80, v48, v48
  v_mul_f32 v81, v49, v49
  v_mul_f32 v82, v50, v50
  ds_read_b64_tr_b16 v[100:101], v8 offset:18432
  ds_read_b64_tr_b16 v[102:103], v8 offset:19456
  v_mfma_f32_32x32x16_bf16 v[32:47], v[108:111], v[140:143], v[32:47]
  v_mul_f32 v83, v51, v51
  v_mul_f32 v84, v52, v52
  v_mul_f32 v85, v53, v53
  v_mul_f32 v86, v54, v54
  v_mul_f32 v87, v55, v55
  ds_read_b64_tr_b16 v[104:105], v8 offset:20480
  ds_read_b64_tr_b16 v[106:107], v8 offset:21504
  v_mfma_f32_32x32x16_bf16 v[32:47], v[112:115], v[144:147], v[32:47]
  v_fma_f32 v80, v80, v14, v13
  v_fma_f32 v81, v81, v14, v13
  v_fma_f32 v82, v82, v14, v13
  v_fma_f32 v83, v83, v14, v13
  v_fma_f32 v84, v84, v14, v13
  v_fma_f32 v85, v85, v14, v13
  ds_read_b64_tr_b16 v[108:109], v8 offset:22528
  ds_read_b64_tr_b16 v[110:111], v8 offset:23552
  s_waitcnt lgkmcnt(10)
  v_mfma_f32_32x32x16_bf16 v[32:47], v[116:119], v[148:151], v[32:47]
  v_fma_f32 v86, v86, v14, v13
  v_fma_f32 v87, v87, v14, v13
  v_mul_f32 v80, v80, v48
  v_mul_f32 v81, v81, v49
  v_mul_f32 v82, v82, v50
  v_mul_f32 v83, v83, v51
  ds_read_b64_tr_b16 v[112:113], v8 offset:24576
  ds_read_b64_tr_b16 v[114:115], v8 offset:25600
  v_mfma_f32_32x32x16_bf16 v[32:47], v[120:123], v[152:155], v[32:47]
  v_mul_f32 v84, v84, v52
  v_mul_f32 v85, v85, v53
  v_mul_f32 v86, v86, v54
  v_mul_f32 v87, v87, v55
  v_exp_f32 v80, v80
  ds_read_b64_tr_b16 v[116:117], v8 offset:26624
  ds_read_b64_tr_b16 v[118:119], v8 offset:27648
  s_waitcnt lgkmcnt(10)
  v_mfma_f32_32x32x16_bf16 v[32:47], v[124:127], v[156:159], v[32:47]
  v_exp_f32 v81, v81
  v_exp_f32 v82, v82
  v_exp_f32 v83, v83
  ds_read_b64_tr_b16 v[120:121], v8 offset:28672
  ds_read_b64_tr_b16 v[122:123], v8 offset:29696
  v_mfma_f32_32x32x16_bf16 v[32:47], v[96:99], v[160:163], v[32:47]
  s_waitcnt vmcnt(0)
  s_add_u32 s16, s8, 0x1703000
  buffer_store_dword v19, v20, s[60:63], s16 offen sc1
  v_exp_f32 v84, v84
  v_exp_f32 v85, v85
  v_exp_f32 v86, v86
  ds_read_b64_tr_b16 v[124:125], v8 offset:30720
  ds_read_b64_tr_b16 v[126:127], v8 offset:31744
  s_waitcnt lgkmcnt(10)
  v_mfma_f32_32x32x16_bf16 v[32:47], v[100:103], v[164:167], v[32:47]
  v_exp_f32 v87, v87
  v_fma_f32 v80, v80, v15, v15
  v_fma_f32 v81, v81, v15, v15
  v_fma_f32 v82, v82, v15, v15
  v_mfma_f32_32x32x16_bf16 v[32:47], v[104:107], v[168:171], v[32:47]
  v_fma_f32 v83, v83, v15, v15
  v_fma_f32 v84, v84, v15, v15
  v_fma_f32 v85, v85, v15, v15
  v_fma_f32 v86, v86, v15, v15
  v_fma_f32 v87, v87, v15, v15
  s_waitcnt lgkmcnt(6)
  v_mfma_f32_32x32x16_bf16 v[32:47], v[108:111], v[172:175], v[32:47]
  v_rcp_f32 v80, v80
  v_rcp_f32 v81, v81
  v_rcp_f32 v82, v82
  v_mfma_f32_32x32x16_bf16 v[32:47], v[112:115], v[176:179], v[32:47]
  v_rcp_f32 v83, v83
  v_rcp_f32 v84, v84
  v_rcp_f32 v85, v85
  s_waitcnt lgkmcnt(0)
  s_barrier
  ds_read_b64_tr_b16 v[96:97], v8 offset:32768
  ds_read_b64_tr_b16 v[98:99], v8 offset:33792
  ds_read_b64_tr_b16 v[100:101], v8 offset:34816
  ds_read_b64_tr_b16 v[102:103], v8 offset:35840
  ds_read_b64_tr_b16 v[104:105], v8 offset:36864
  ds_read_b64_tr_b16 v[106:107], v8 offset:37888
  ds_read_b64_tr_b16 v[108:109], v8 offset:38912
  ds_read_b64_tr_b16 v[110:111], v8 offset:39936
  v_mfma_f32_32x32x16_bf16 v[32:47], v[116:119], v[180:183], v[32:47]
  v_rcp_f32 v86, v86
  v_rcp_f32 v87, v87
  v_mul_f32 v48, v48, v80
  v_mul_f32 v49, v49, v81
  ds_read_b64_tr_b16 v[112:113], v8 offset:40960
  ds_read_b64_tr_b16 v[114:115], v8 offset:41984
  v_mfma_f32_32x32x16_bf16 v[32:47], v[120:123], v[184:187], v[32:47]
  v_mul_f32 v50, v50, v82
  v_mul_f32 v51, v51, v83
  v_mul_f32 v52, v52, v84
  v_mul_f32 v53, v53, v85
  v_mul_f32 v54, v54, v86
  v_mul_f32 v55, v55, v87
  ds_read_b64_tr_b16 v[116:117], v8 offset:43008
  ds_read_b64_tr_b16 v[118:119], v8 offset:44032
  v_mfma_f32_32x32x16_bf16 v[32:47], v[124:127], v[188:191], v[32:47]
  v_cvt_pk_bf16_f32 v88, v48, v49
  v_cvt_pk_bf16_f32 v89, v50, v51
  v_cvt_pk_bf16_f32 v90, v52, v53
  v_cvt_pk_bf16_f32 v91, v54, v55
  buffer_store_dwordx4 v[88:91], v4, s[60:63], s15 offen sc1
  ds_read_b64_tr_b16 v[120:121], v8 offset:45056
  ds_read_b64_tr_b16 v[122:123], v8 offset:46080
  s_waitcnt lgkmcnt(10)
  v_mfma_f32_32x32x16_bf16 v[32:47], v[96:99], v[192:195], v[32:47]
  v_fma_f32 v56, -v12, v72, v56
  v_fma_f32 v57, -v12, v73, v57
  v_fma_f32 v58, -v12, v74, v58
  v_fma_f32 v59, -v12, v75, v59
  v_fma_f32 v60, -v12, v76, v60
  ds_read_b64_tr_b16 v[124:125], v8 offset:47104
  ds_read_b64_tr_b16 v[126:127], v8 offset:48128
  v_mfma_f32_32x32x16_bf16 v[32:47], v[100:103], v[196:199], v[32:47]
  v_fma_f32 v61, -v12, v77, v61
  v_fma_f32 v62, -v12, v78, v62
  v_fma_f32 v63, -v12, v79, v63
  v_mul_f32 v80, v56, v56
  v_mul_f32 v81, v57, v57
  v_mul_f32 v82, v58, v58
  ds_read_b64_tr_b16 v[96:97], v8 offset:49152
  ds_read_b64_tr_b16 v[98:99], v8 offset:50176
  s_waitcnt lgkmcnt(10)
  v_mfma_f32_32x32x16_bf16 v[32:47], v[104:107], v[200:203], v[32:47]
  v_mul_f32 v83, v59, v59
  v_mul_f32 v84, v60, v60
  v_mul_f32 v85, v61, v61
  v_mul_f32 v86, v62, v62
  v_mul_f32 v87, v63, v63
  v_fma_f32 v80, v80, v14, v13
  ds_read_b64_tr_b16 v[100:101], v8 offset:51200
  ds_read_b64_tr_b16 v[102:103], v8 offset:52224
  v_mfma_f32_32x32x16_bf16 v[32:47], v[108:111], v[204:207], v[32:47]
  v_fma_f32 v81, v81, v14, v13
  v_fma_f32 v82, v82, v14, v13
  v_fma_f32 v83, v83, v14, v13
  v_fma_f32 v84, v84, v14, v13
  v_fma_f32 v85, v85, v14, v13
  v_fma_f32 v86, v86, v14, v13
  ds_read_b64_tr_b16 v[104:105], v8 offset:53248
  ds_read_b64_tr_b16 v[106:107], v8 offset:54272
  s_waitcnt lgkmcnt(10)
  v_mfma_f32_32x32x16_bf16 v[32:47], v[112:115], v[208:211], v[32:47]
  v_fma_f32 v87, v87, v14, v13
  v_mul_f32 v80, v80, v56
  v_mul_f32 v81, v81, v57
  v_mul_f32 v82, v82, v58
  v_mul_f32 v83, v83, v59
  ds_read_b64_tr_b16 v[108:109], v8 offset:55296
  ds_read_b64_tr_b16 v[110:111], v8 offset:56320
  v_mfma_f32_32x32x16_bf16 v[32:47], v[116:119], v[212:215], v[32:47]
  v_mul_f32 v84, v84, v60
  v_mul_f32 v85, v85, v61
  v_mul_f32 v86, v86, v62
  v_mul_f32 v87, v87, v63
  v_exp_f32 v80, v80
  ds_read_b64_tr_b16 v[112:113], v8 offset:57344
  ds_read_b64_tr_b16 v[114:115], v8 offset:58368
  s_waitcnt lgkmcnt(10)
  v_mfma_f32_32x32x16_bf16 v[32:47], v[120:123], v[216:219], v[32:47]
  v_exp_f32 v81, v81
  v_exp_f32 v82, v82
  v_exp_f32 v83, v83
  ds_read_b64_tr_b16 v[116:117], v8 offset:59392
  ds_read_b64_tr_b16 v[118:119], v8 offset:60416
  v_mfma_f32_32x32x16_bf16 v[32:47], v[124:127], v[220:223], v[32:47]
  v_exp_f32 v84, v84
  v_exp_f32 v85, v85
  v_exp_f32 v86, v86
  ds_read_b64_tr_b16 v[120:121], v8 offset:61440
  ds_read_b64_tr_b16 v[122:123], v8 offset:62464
  s_waitcnt lgkmcnt(10)
  v_mfma_f32_32x32x16_bf16 v[32:47], v[96:99], v[224:227], v[32:47]
  v_exp_f32 v87, v87
  v_fma_f32 v80, v80, v15, v15
  v_fma_f32 v81, v81, v15, v15
  v_fma_f32 v82, v82, v15, v15
  ds_read_b64_tr_b16 v[124:125], v8 offset:63488
  ds_read_b64_tr_b16 v[126:127], v8 offset:64512
  v_mfma_f32_32x32x16_bf16 v[32:47], v[100:103], v[228:231], v[32:47]
  v_fma_f32 v83, v83, v15, v15
  v_fma_f32 v84, v84, v15, v15
  v_fma_f32 v85, v85, v15, v15
  v_fma_f32 v86, v86, v15, v15
  v_fma_f32 v87, v87, v15, v15
  v_rcp_f32 v80, v80
  s_waitcnt lgkmcnt(8)
  v_mfma_f32_32x32x16_bf16 v[32:47], v[104:107], v[232:235], v[32:47]
  v_rcp_f32 v81, v81
  v_rcp_f32 v82, v82
  v_mfma_f32_32x32x16_bf16 v[32:47], v[108:111], v[236:239], v[32:47]
  v_rcp_f32 v83, v83
  v_rcp_f32 v84, v84
  v_rcp_f32 v85, v85
  s_waitcnt lgkmcnt(4)
  v_mfma_f32_32x32x16_bf16 v[32:47], v[112:115], v[240:243], v[32:47]
  v_rcp_f32 v86, v86
  v_rcp_f32 v87, v87
  v_mul_f32 v56, v56, v80
  v_mul_f32 v57, v57, v81
  s_waitcnt lgkmcnt(0)
  s_barrier
  ds_read_b64_tr_b16 v[96:97], v9 offset:0
  ds_read_b64_tr_b16 v[98:99], v9 offset:1024
  ds_read_b64_tr_b16 v[100:101], v9 offset:2048
  ds_read_b64_tr_b16 v[102:103], v9 offset:3072
  ds_read_b64_tr_b16 v[104:105], v9 offset:4096
  ds_read_b64_tr_b16 v[106:107], v9 offset:5120
  ds_read_b64_tr_b16 v[108:109], v9 offset:6144
  ds_read_b64_tr_b16 v[110:111], v9 offset:7168
  v_mfma_f32_32x32x16_bf16 v[32:47], v[116:119], v[244:247], v[32:47]
  v_mul_f32 v58, v58, v82
  v_mul_f32 v59, v59, v83
  v_mul_f32 v60, v60, v84
  v_mul_f32 v61, v61, v85
  v_mul_f32 v62, v62, v86
  v_mul_f32 v63, v63, v87
  ds_read_b64_tr_b16 v[112:113], v9 offset:8192
  ds_read_b64_tr_b16 v[114:115], v9 offset:9216
  v_mfma_f32_32x32x16_bf16 v[32:47], v[120:123], v[248:251], v[32:47]
  v_cvt_pk_bf16_f32 v92, v56, v57
  v_cvt_pk_bf16_f32 v93, v58, v59
  v_cvt_pk_bf16_f32 v94, v60, v61
  v_cvt_pk_bf16_f32 v95, v62, v63
  buffer_store_dwordx4 v[92:95], v4, s[60:63], s15 offen offset:1024 sc1
  ds_read_b128 v[64:67], v16 offset:512
  ds_read_b128 v[68:71], v16 offset:544
  ds_read_b128 v[72:75], v16 offset:576
  ds_read_b128 v[76:79], v16 offset:608
  ds_read_b64_tr_b16 v[116:117], v9 offset:10240
  s_waitcnt lgkmcnt(14)
  ds_read_b64_tr_b16 v[118:119], v9 offset:11264
  v_mfma_f32_32x32x16_bf16 v[48:63], v[124:127], v[252:255], v[32:47]
  s_waitcnt lgkmcnt(14)
  ds_read_b64_tr_b16 v[120:121], v9 offset:12288
  s_waitcnt lgkmcnt(14)
  ds_read_b64_tr_b16 v[122:123], v9 offset:13312
  v_mfma_f32_32x32x16_bf16 v[32:47], v[96:99], v[128:131], 0
  s_waitcnt lgkmcnt(14)
  ds_read_b64_tr_b16 v[124:125], v9 offset:14336
  s_waitcnt lgkmcnt(14)
  ds_read_b64_tr_b16 v[126:127], v9 offset:15360
  v_mfma_f32_32x32x16_bf16 v[32:47], v[100:103], v[132:135], v[32:47]
  s_add_u32 s15, s14, 8192
  s_waitcnt lgkmcnt(6)
  v_fma_f32 v48, -v12, v64, v48
  v_fma_f32 v49, -v12, v65, v49
  v_fma_f32 v50, -v12, v66, v50
  v_fma_f32 v51, -v12, v67, v51
  v_fma_f32 v52, -v12, v68, v52
  ds_read_b64_tr_b16 v[96:97], v9 offset:16384
  ds_read_b64_tr_b16 v[98:99], v9 offset:17408
  v_mfma_f32_32x32x16_bf16 v[32:47], v[104:107], v[136:139], v[32:47]
  v_fma_f32 v53, -v12, v69, v53
  v_fma_f32 v54, -v12, v70, v54
  v_fma_f32 v55, -v12, v71, v55
  v_mul_f32 v80, v48, v48
  v_mul_f32 v81, v49, v49
  v_mul_f32 v82, v50, v50
  ds_read_b64_tr_b16 v[100:101], v9 offset:18432
  ds_read_b64_tr_b16 v[102:103], v9 offset:19456
  v_mfma_f32_32x32x16_bf16 v[32:47], v[108:111], v[140:143], v[32:47]
  v_mul_f32 v83, v51, v51
  v_mul_f32 v84, v52, v52
  v_mul_f32 v85, v53, v53
  v_mul_f32 v86, v54, v54
  v_mul_f32 v87, v55, v55
  ds_read_b64_tr_b16 v[104:105], v9 offset:20480
  ds_read_b64_tr_b16 v[106:107], v9 offset:21504
  v_mfma_f32_32x32x16_bf16 v[32:47], v[112:115], v[144:147], v[32:47]
  v_fma_f32 v80, v80, v14, v13
  v_fma_f32 v81, v81, v14, v13
  v_fma_f32 v82, v82, v14, v13
  v_fma_f32 v83, v83, v14, v13
  v_fma_f32 v84, v84, v14, v13
  v_fma_f32 v85, v85, v14, v13
  ds_read_b64_tr_b16 v[108:109], v9 offset:22528
  ds_read_b64_tr_b16 v[110:111], v9 offset:23552
  s_waitcnt lgkmcnt(10)
  v_mfma_f32_32x32x16_bf16 v[32:47], v[116:119], v[148:151], v[32:47]
  v_fma_f32 v86, v86, v14, v13
  v_fma_f32 v87, v87, v14, v13
  v_mul_f32 v80, v80, v48
  v_mul_f32 v81, v81, v49
  v_mul_f32 v82, v82, v50
  v_mul_f32 v83, v83, v51
  ds_read_b64_tr_b16 v[112:113], v9 offset:24576
  ds_read_b64_tr_b16 v[114:115], v9 offset:25600
  v_mfma_f32_32x32x16_bf16 v[32:47], v[120:123], v[152:155], v[32:47]
  v_mul_f32 v84, v84, v52
  v_mul_f32 v85, v85, v53
  v_mul_f32 v86, v86, v54
  v_mul_f32 v87, v87, v55
  v_exp_f32 v80, v80
  ds_read_b64_tr_b16 v[116:117], v9 offset:26624
  ds_read_b64_tr_b16 v[118:119], v9 offset:27648
  s_waitcnt lgkmcnt(10)
  v_mfma_f32_32x32x16_bf16 v[32:47], v[124:127], v[156:159], v[32:47]
  v_exp_f32 v81, v81
  v_exp_f32 v82, v82
  v_exp_f32 v83, v83
  ds_read_b64_tr_b16 v[120:121], v9 offset:28672
  ds_read_b64_tr_b16 v[122:123], v9 offset:29696
  v_mfma_f32_32x32x16_bf16 v[32:47], v[96:99], v[160:163], v[32:47]
  v_exp_f32 v84, v84
  v_exp_f32 v85, v85
  v_exp_f32 v86, v86
  ds_read_b64_tr_b16 v[124:125], v9 offset:30720
  ds_read_b64_tr_b16 v[126:127], v9 offset:31744
  s_waitcnt lgkmcnt(10)
  v_mfma_f32_32x32x16_bf16 v[32:47], v[100:103], v[164:167], v[32:47]
  v_exp_f32 v87, v87
  v_fma_f32 v80, v80, v15, v15
  v_fma_f32 v81, v81, v15, v15
  v_fma_f32 v82, v82, v15, v15
  v_mfma_f32_32x32x16_bf16 v[32:47], v[104:107], v[168:171], v[32:47]
  v_fma_f32 v83, v83, v15, v15
  v_fma_f32 v84, v84, v15, v15
  v_fma_f32 v85, v85, v15, v15
  v_fma_f32 v86, v86, v15, v15
  v_fma_f32 v87, v87, v15, v15
  s_waitcnt lgkmcnt(6)
  v_mfma_f32_32x32x16_bf16 v[32:47], v[108:111], v[172:175], v[32:47]
  v_rcp_f32 v80, v80
  v_rcp_f32 v81, v81
  v_rcp_f32 v82, v82
  v_mfma_f32_32x32x16_bf16 v[32:47], v[112:115], v[176:179], v[32:47]
  v_rcp_f32 v83, v83
  v_rcp_f32 v84, v84
  v_rcp_f32 v85, v85
  s_waitcnt lgkmcnt(0)
  s_barrier
  ds_read_b64_tr_b16 v[96:97], v9 offset:32768
  ds_read_b64_tr_b16 v[98:99], v9 offset:33792
  ds_read_b64_tr_b16 v[100:101], v9 offset:34816
  ds_read_b64_tr_b16 v[102:103], v9 offset:35840
  ds_read_b64_tr_b16 v[104:105], v9 offset:36864
  ds_read_b64_tr_b16 v[106:107], v9 offset:37888
  ds_read_b64_tr_b16 v[108:109], v9 offset:38912
  ds_read_b64_tr_b16 v[110:111], v9 offset:39936
  v_mfma_f32_32x32x16_bf16 v[32:47], v[116:119], v[180:183], v[32:47]
  v_rcp_f32 v86, v86
  v_rcp_f32 v87, v87
  v_mul_f32 v48, v48, v80
  v_mul_f32 v49, v49, v81
  ds_read_b64_tr_b16 v[112:113], v9 offset:40960
  ds_read_b64_tr_b16 v[114:115], v9 offset:41984
  v_mfma_f32_32x32x16_bf16 v[32:47], v[120:123], v[184:187], v[32:47]
  v_mul_f32 v50, v50, v82
  v_mul_f32 v51, v51, v83
  v_mul_f32 v52, v52, v84
  v_mul_f32 v53, v53, v85
  v_mul_f32 v54, v54, v86
  v_mul_f32 v55, v55, v87
  ds_read_b64_tr_b16 v[116:117], v9 offset:43008
  ds_read_b64_tr_b16 v[118:119], v9 offset:44032
  v_mfma_f32_32x32x16_bf16 v[32:47], v[124:127], v[188:191], v[32:47]
  v_cvt_pk_bf16_f32 v88, v48, v49
  v_cvt_pk_bf16_f32 v89, v50, v51
  v_cvt_pk_bf16_f32 v90, v52, v53
  v_cvt_pk_bf16_f32 v91, v54, v55
  buffer_store_dwordx4 v[88:91], v4, s[60:63], s15 offen sc1
  ds_read_b64_tr_b16 v[120:121], v9 offset:45056
  ds_read_b64_tr_b16 v[122:123], v9 offset:46080
  s_waitcnt lgkmcnt(10)
  v_mfma_f32_32x32x16_bf16 v[32:47], v[96:99], v[192:195], v[32:47]
  v_fma_f32 v56, -v12, v72, v56
  v_fma_f32 v57, -v12, v73, v57
  v_fma_f32 v58, -v12, v74, v58
  v_fma_f32 v59, -v12, v75, v59
  v_fma_f32 v60, -v12, v76, v60
  ds_read_b64_tr_b16 v[124:125], v9 offset:47104
  ds_read_b64_tr_b16 v[126:127], v9 offset:48128
  v_mfma_f32_32x32x16_bf16 v[32:47], v[100:103], v[196:199], v[32:47]
  v_fma_f32 v61, -v12, v77, v61
  v_fma_f32 v62, -v12, v78, v62
  v_fma_f32 v63, -v12, v79, v63
  v_mul_f32 v80, v56, v56
  v_mul_f32 v81, v57, v57
  v_mul_f32 v82, v58, v58
  ds_read_b64_tr_b16 v[96:97], v9 offset:49152
  ds_read_b64_tr_b16 v[98:99], v9 offset:50176
  s_waitcnt lgkmcnt(10)
  v_mfma_f32_32x32x16_bf16 v[32:47], v[104:107], v[200:203], v[32:47]
  v_mul_f32 v83, v59, v59
  v_mul_f32 v84, v60, v60
  v_mul_f32 v85, v61, v61
  v_mul_f32 v86, v62, v62
  v_mul_f32 v87, v63, v63
  v_fma_f32 v80, v80, v14, v13
  ds_read_b64_tr_b16 v[100:101], v9 offset:51200
  ds_read_b64_tr_b16 v[102:103], v9 offset:52224
  v_mfma_f32_32x32x16_bf16 v[32:47], v[108:111], v[204:207], v[32:47]
  v_fma_f32 v81, v81, v14, v13
  v_fma_f32 v82, v82, v14, v13
  v_fma_f32 v83, v83, v14, v13
  v_fma_f32 v84, v84, v14, v13
  v_fma_f32 v85, v85, v14, v13
  v_fma_f32 v86, v86, v14, v13
  ds_read_b64_tr_b16 v[104:105], v9 offset:53248
  ds_read_b64_tr_b16 v[106:107], v9 offset:54272
  s_waitcnt lgkmcnt(10)
  v_mfma_f32_32x32x16_bf16 v[32:47], v[112:115], v[208:211], v[32:47]
  v_fma_f32 v87, v87, v14, v13
  v_mul_f32 v80, v80, v56
  v_mul_f32 v81, v81, v57
  v_mul_f32 v82, v82, v58
  v_mul_f32 v83, v83, v59
  ds_read_b64_tr_b16 v[108:109], v9 offset:55296
  ds_read_b64_tr_b16 v[110:111], v9 offset:56320
  v_mfma_f32_32x32x16_bf16 v[32:47], v[116:119], v[212:215], v[32:47]
  v_mul_f32 v84, v84, v60
  v_mul_f32 v85, v85, v61
  v_mul_f32 v86, v86, v62
  v_mul_f32 v87, v87, v63
  v_exp_f32 v80, v80
  ds_read_b64_tr_b16 v[112:113], v9 offset:57344
  ds_read_b64_tr_b16 v[114:115], v9 offset:58368
  s_waitcnt lgkmcnt(10)
  v_mfma_f32_32x32x16_bf16 v[32:47], v[120:123], v[216:219], v[32:47]
  s_waitcnt vmcnt(1)
  s_add_u32 s16, s8, 0x1704000
  buffer_store_dword v19, v20, s[60:63], s16 offen sc1
  v_exp_f32 v81, v81
  v_exp_f32 v82, v82
  v_exp_f32 v83, v83
  ds_read_b64_tr_b16 v[116:117], v9 offset:59392
  ds_read_b64_tr_b16 v[118:119], v9 offset:60416
  v_mfma_f32_32x32x16_bf16 v[32:47], v[124:127], v[220:223], v[32:47]
  v_exp_f32 v84, v84
  v_exp_f32 v85, v85
  v_exp_f32 v86, v86
  ds_read_b64_tr_b16 v[120:121], v9 offset:61440
  ds_read_b64_tr_b16 v[122:123], v9 offset:62464
  s_waitcnt lgkmcnt(10)
  v_mfma_f32_32x32x16_bf16 v[32:47], v[96:99], v[224:227], v[32:47]
  v_exp_f32 v87, v87
  v_fma_f32 v80, v80, v15, v15
  v_fma_f32 v81, v81, v15, v15
  v_fma_f32 v82, v82, v15, v15
  buffer_load_dword v17, v3, s[60:63], s10 offen sc1
  ds_read_b64_tr_b16 v[124:125], v9 offset:63488
  ds_read_b64_tr_b16 v[126:127], v9 offset:64512
  v_mfma_f32_32x32x16_bf16 v[32:47], v[100:103], v[228:231], v[32:47]
  v_fma_f32 v83, v83, v15, v15
  v_fma_f32 v84, v84, v15, v15
  v_fma_f32 v85, v85, v15, v15
  v_fma_f32 v86, v86, v15, v15
  v_fma_f32 v87, v87, v15, v15
  v_rcp_f32 v80, v80
  s_waitcnt lgkmcnt(8)
  v_mfma_f32_32x32x16_bf16 v[32:47], v[104:107], v[232:235], v[32:47]
  v_rcp_f32 v81, v81
  v_rcp_f32 v82, v82
  v_mfma_f32_32x32x16_bf16 v[32:47], v[108:111], v[236:239], v[32:47]
  v_rcp_f32 v83, v83
  v_rcp_f32 v84, v84
  v_rcp_f32 v85, v85
  s_waitcnt lgkmcnt(4)
  v_mfma_f32_32x32x16_bf16 v[32:47], v[112:115], v[240:243], v[32:47]
  v_rcp_f32 v86, v86
  v_rcp_f32 v87, v87
  v_mul_f32 v56, v56, v80
  v_mul_f32 v57, v57, v81
  v_mfma_f32_32x32x16_bf16 v[32:47], v[116:119], v[244:247], v[32:47]
  v_mul_f32 v58, v58, v82
  v_mul_f32 v59, v59, v83
  v_mul_f32 v60, v60, v84
  v_mul_f32 v61, v61, v85
  v_mul_f32 v62, v62, v86
  v_mul_f32 v63, v63, v87
  s_waitcnt lgkmcnt(0)
  v_mfma_f32_32x32x16_bf16 v[32:47], v[120:123], v[248:251], v[32:47]
  v_cvt_pk_bf16_f32 v92, v56, v57
  v_cvt_pk_bf16_f32 v93, v58, v59
  v_cvt_pk_bf16_f32 v94, v60, v61
  v_cvt_pk_bf16_f32 v95, v62, v63
  buffer_store_dwordx4 v[92:95], v4, s[60:63], s15 offen offset:1024 sc1
  ds_read_b128 v[64:67], v16 offset:768
  ds_read_b128 v[68:71], v16 offset:800
  ds_read_b128 v[72:75], v16 offset:832
  ds_read_b128 v[76:79], v16 offset:864
  v_mfma_f32_32x32x16_bf16 v[48:63], v[124:127], v[252:255], v[32:47]
  s_add_u32 s15, s14, 12288
  s_waitcnt lgkmcnt(0)
  s_nop 9
  v_fma_f32 v48, -v12, v64, v48
  v_fma_f32 v49, -v12, v65, v49
  v_fma_f32 v50, -v12, v66, v50
  v_fma_f32 v51, -v12, v67, v51
  v_fma_f32 v52, -v12, v68, v52
  v_fma_f32 v53, -v12, v69, v53
  v_fma_f32 v54, -v12, v70, v54
  v_fma_f32 v55, -v12, v71, v55
  v_mul_f32 v80, v48, v48
  v_mul_f32 v81, v49, v49
  v_mul_f32 v82, v50, v50
  v_mul_f32 v83, v51, v51
  v_mul_f32 v84, v52, v52
  v_mul_f32 v85, v53, v53
  v_mul_f32 v86, v54, v54
  v_mul_f32 v87, v55, v55
  v_fma_f32 v80, v80, v14, v13
  v_fma_f32 v81, v81, v14, v13
  v_fma_f32 v82, v82, v14, v13
  v_fma_f32 v83, v83, v14, v13
  v_fma_f32 v84, v84, v14, v13
  v_fma_f32 v85, v85, v14, v13
  v_fma_f32 v86, v86, v14, v13
  v_fma_f32 v87, v87, v14, v13
  v_mul_f32 v80, v80, v48
  v_mul_f32 v81, v81, v49
  v_mul_f32 v82, v82, v50
  v_mul_f32 v83, v83, v51
  v_mul_f32 v84, v84, v52
  v_mul_f32 v85, v85, v53
  v_mul_f32 v86, v86, v54
  v_mul_f32 v87, v87, v55
  v_exp_f32 v80, v80
  v_exp_f32 v81, v81
  v_exp_f32 v82, v82
  v_exp_f32 v83, v83
  v_exp_f32 v84, v84
  v_exp_f32 v85, v85
  v_exp_f32 v86, v86
  v_exp_f32 v87, v87
  v_fma_f32 v80, v80, v15, v15
  v_fma_f32 v81, v81, v15, v15
  v_fma_f32 v82, v82, v15, v15
  v_fma_f32 v83, v83, v15, v15
  v_fma_f32 v84, v84, v15, v15
  v_fma_f32 v85, v85, v15, v15
  v_fma_f32 v86, v86, v15, v15
  v_fma_f32 v87, v87, v15, v15
  v_rcp_f32 v80, v80
  v_rcp_f32 v81, v81
  v_rcp_f32 v82, v82
  v_rcp_f32 v83, v83
  v_rcp_f32 v84, v84
  v_rcp_f32 v85, v85
  v_rcp_f32 v86, v86
  v_rcp_f32 v87, v87
  v_mul_f32 v48, v48, v80
  v_mul_f32 v49, v49, v81
  v_mul_f32 v50, v50, v82
  v_mul_f32 v51, v51, v83
  v_mul_f32 v52, v52, v84
  v_mul_f32 v53, v53, v85
  v_mul_f32 v54, v54, v86
  v_mul_f32 v55, v55, v87
  v_cvt_pk_bf16_f32 v88, v48, v49
  v_cvt_pk_bf16_f32 v89, v50, v51
  v_cvt_pk_bf16_f32 v90, v52, v53
  v_cvt_pk_bf16_f32 v91, v54, v55
  buffer_store_dwordx4 v[88:91], v4, s[60:63], s15 offen sc1
  v_fma_f32 v56, -v12, v72, v56
  v_fma_f32 v57, -v12, v73, v57
  v_fma_f32 v58, -v12, v74, v58
  v_fma_f32 v59, -v12, v75, v59
  v_fma_f32 v60, -v12, v76, v60
  v_fma_f32 v61, -v12, v77, v61
  v_fma_f32 v62, -v12, v78, v62
  v_fma_f32 v63, -v12, v79, v63
  v_mul_f32 v80, v56, v56
  v_mul_f32 v81, v57, v57
  v_mul_f32 v82, v58, v58
  v_mul_f32 v83, v59, v59
  v_mul_f32 v84, v60, v60
  v_mul_f32 v85, v61, v61
  v_mul_f32 v86, v62, v62
  v_mul_f32 v87, v63, v63
  v_fma_f32 v80, v80, v14, v13
  v_fma_f32 v81, v81, v14, v13
  v_fma_f32 v82, v82, v14, v13
  v_fma_f32 v83, v83, v14, v13
  v_fma_f32 v84, v84, v14, v13
  v_fma_f32 v85, v85, v14, v13
  v_fma_f32 v86, v86, v14, v13
  v_fma_f32 v87, v87, v14, v13
  v_mul_f32 v80, v80, v56
  v_mul_f32 v81, v81, v57
  v_mul_f32 v82, v82, v58
  v_mul_f32 v83, v83, v59
  v_mul_f32 v84, v84, v60
  v_mul_f32 v85, v85, v61
  v_mul_f32 v86, v86, v62
  v_mul_f32 v87, v87, v63
  v_exp_f32 v80, v80
  v_exp_f32 v81, v81
  v_exp_f32 v82, v82
  v_exp_f32 v83, v83
  v_exp_f32 v84, v84
  v_exp_f32 v85, v85
  v_exp_f32 v86, v86
  v_exp_f32 v87, v87
  v_fma_f32 v80, v80, v15, v15
  v_fma_f32 v81, v81, v15, v15
  v_fma_f32 v82, v82, v15, v15
  v_fma_f32 v83, v83, v15, v15
  v_fma_f32 v84, v84, v15, v15
  v_fma_f32 v85, v85, v15, v15
  v_fma_f32 v86, v86, v15, v15
  v_fma_f32 v87, v87, v15, v15
  v_rcp_f32 v80, v80
  v_rcp_f32 v81, v81
  v_rcp_f32 v82, v82
  v_rcp_f32 v83, v83
  v_rcp_f32 v84, v84
  v_rcp_f32 v85, v85
  v_rcp_f32 v86, v86
  v_rcp_f32 v87, v87
  v_mul_f32 v56, v56, v80
  v_mul_f32 v57, v57, v81
  v_mul_f32 v58, v58, v82
  v_mul_f32 v59, v59, v83
  v_mul_f32 v60, v60, v84
  v_mul_f32 v61, v61, v85
  v_mul_f32 v62, v62, v86
  v_mul_f32 v63, v63, v87
  v_cvt_pk_bf16_f32 v92, v56, v57
  v_cvt_pk_bf16_f32 v93, v58, v59
  v_cvt_pk_bf16_f32 v94, v60, v61
  v_cvt_pk_bf16_f32 v95, v62, v63
  buffer_store_dwordx4 v[92:95], v4, s[60:63], s15 offen offset:1024 sc1
  s_barrier
  ds_read_b128 v[64:67], v10 offset:0
  ds_read_b64_tr_b16 v[96:97], v8 offset:0
  ds_read_b64_tr_b16 v[98:99], v8 offset:1024
  ds_read_b128 v[68:71], v10 offset:1024
  ds_read_b64_tr_b16 v[100:101], v8 offset:2048
  ds_read_b64_tr_b16 v[102:103], v8 offset:3072
  ds_read_b128 v[72:75], v10 offset:2048
  ds_read_b64_tr_b16 v[104:105], v8 offset:4096
  ds_read_b64_tr_b16 v[106:107], v8 offset:5120
  ds_read_b128 v[76:79], v10 offset:3072
  ds_read_b64_tr_b16 v[108:109], v8 offset:6144
  ds_read_b64_tr_b16 v[110:111], v8 offset:7168
  s_waitcnt lgkmcnt(9)
  v_mfma_f32_32x32x16_bf16 v[32:47], v[96:99], v[64:67], 0
  s_waitcnt vmcnt(2)
  s_add_u32 s16, s8, 0x1705000
  buffer_store_dword v19, v20, s[60:63], s16 offen sc1
  ds_read_b128 v[80:83], v10 offset:16384
  ds_read_b64_tr_b16 v[112:113], v8 offset:16384
  ds_read_b64_tr_b16 v[114:115], v8 offset:17408
  ds_read_b128 v[84:87], v10 offset:17408
  ds_read_b64_tr_b16 v[116:117], v8 offset:18432
  ds_read_b64_tr_b16 v[118:119], v8 offset:19456
  s_waitcnt lgkmcnt(12)
  v_mfma_f32_32x32x16_bf16 v[32:47], v[100:103], v[68:71], v[32:47]
  ds_read_b128 v[88:91], v10 offset:18432
  ds_read_b64_tr_b16 v[120:121], v8 offset:20480
  ds_read_b64_tr_b16 v[122:123], v8 offset:21504
  s_waitcnt lgkmcnt(12)
  v_mfma_f32_32x32x16_bf16 v[32:47], v[104:107], v[72:75], v[32:47]
  ds_read_b128 v[92:95], v10 offset:19456
  ds_read_b64_tr_b16 v[124:125], v8 offset:22528
  ds_read_b64_tr_b16 v[126:127], v8 offset:23552
  s_waitcnt lgkmcnt(12)
  v_mfma_f32_32x32x16_bf16 v[32:47], v[108:111], v[76:79], v[32:47]
  s_waitcnt lgkmcnt(6)
  v_mfma_f32_32x32x16_bf16 v[32:47], v[112:115], v[80:83], v[32:47]
  v_mfma_f32_32x32x16_bf16 v[32:47], v[116:119], v[84:87], v[32:47]
  s_waitcnt lgkmcnt(0)
  s_barrier
  ds_read_b128 v[64:67], v10 offset:32768
  ds_read_b64_tr_b16 v[96:97], v8 offset:32768
  ds_read_b64_tr_b16 v[98:99], v8 offset:33792
  ds_read_b128 v[68:71], v10 offset:33792
  ds_read_b64_tr_b16 v[100:101], v8 offset:34816
  ds_read_b64_tr_b16 v[102:103], v8 offset:35840
  ds_read_b128 v[72:75], v10 offset:34816
  ds_read_b64_tr_b16 v[104:105], v8 offset:36864
  ds_read_b64_tr_b16 v[106:107], v8 offset:37888
  v_mfma_f32_32x32x16_bf16 v[32:47], v[120:123], v[88:91], v[32:47]
  ds_read_b128 v[76:79], v10 offset:35840
  ds_read_b64_tr_b16 v[108:109], v8 offset:38912
  ds_read_b64_tr_b16 v[110:111], v8 offset:39936
  v_mfma_f32_32x32x16_bf16 v[32:47], v[124:127], v[92:95], v[32:47]
  ds_read_b128 v[80:83], v10 offset:49152
  ds_read_b64_tr_b16 v[112:113], v8 offset:49152
  ds_read_b64_tr_b16 v[114:115], v8 offset:50176
  s_waitcnt lgkmcnt(12)
  v_mfma_f32_32x32x16_bf16 v[32:47], v[96:99], v[64:67], v[32:47]
  ds_read_b128 v[84:87], v10 offset:50176
  ds_read_b64_tr_b16 v[116:117], v8 offset:51200
  ds_read_b64_tr_b16 v[118:119], v8 offset:52224
  s_waitcnt lgkmcnt(9)
  v_mfma_f32_32x32x16_bf16 v[32:47], v[100:103], v[68:71], v[32:47]
  ds_read_b128 v[88:91], v10 offset:51200
  ds_read_b64_tr_b16 v[120:121], v8 offset:53248
  ds_read_b64_tr_b16 v[122:123], v8 offset:54272
  v_mfma_f32_32x32x16_bf16 v[32:47], v[104:107], v[72:75], v[32:47]
  ds_read_b128 v[92:95], v10 offset:52224
  ds_read_b64_tr_b16 v[124:125], v8 offset:55296
  ds_read_b64_tr_b16 v[126:127], v8 offset:56320
  s_waitcnt lgkmcnt(9)
  v_mfma_f32_32x32x16_bf16 v[32:47], v[108:111], v[76:79], v[32:47]
  v_mfma_f32_32x32x16_bf16 v[32:47], v[112:115], v[80:83], v[32:47]
  s_waitcnt lgkmcnt(3)
  v_mfma_f32_32x32x16_bf16 v[32:47], v[116:119], v[84:87], v[32:47]
  s_waitcnt lgkmcnt(0)
  s_barrier
  ds_read_b128 v[64:67], v11 offset:0
  ds_read_b64_tr_b16 v[96:97], v9 offset:0
  ds_read_b64_tr_b16 v[98:99], v9 offset:1024
  ds_read_b128 v[68:71], v11 offset:1024
  ds_read_b64_tr_b16 v[100:101], v9 offset:2048
  ds_read_b64_tr_b16 v[102:103], v9 offset:3072
  ds_read_b128 v[72:75], v11 offset:2048
  ds_read_b64_tr_b16 v[104:105], v9 offset:4096
  ds_read_b64_tr_b16 v[106:107], v9 offset:5120
  v_mfma_f32_32x32x16_bf16 v[32:47], v[120:123], v[88:91], v[32:47]
  v_cmp_ne_u32 vcc, s29, v17
  s_and_b64 vcc, vcc, 0xffff
  s_cbranch_scc0 KFOK_3
  s_mov_b32 s80, 0xffff
  s_mov_b32 s81, 0x0
PL_4:
  buffer_load_dword v17, v3, s[60:63], s10 offen sc1
  s_waitcnt vmcnt(0)
  v_cmp_ne_u32 vcc, s29, v17
  s_and_b64 vcc, vcc, s[80:81]
  s_cbranch_scc0 PD_5
  s_sub_u32 s78, s78, 1
  s_cmp_gt_i32 s78, 0
  s_cbranch_scc1 PL_4
PD_5:
KFOK_3:
  buffer_load_dwordx4 v[128:131], v21, s[60:63], s11 offen sc1
  buffer_load_dwordx4 v[132:135], v21, s[60:63], s11 offen offset:1024 sc1
  ds_read_b128 v[76:79], v11 offset:3072
  ds_read_b64_tr_b16 v[108:109], v9 offset:6144
  ds_read_b64_tr_b16 v[110:111], v9 offset:7168
  v_mfma_f32_32x32x16_bf16 v[32:47], v[124:127], v[92:95], v[32:47]
  s_lshl_b32 s72, s26, 12
  s_add_u32 s72, s72, 131072
  v_add_u32 v31, s72, v21
  ds_read_b128 v[136:139], v31
  ds_read_b128 v[140:143], v31 offset:1024
  ds_read_b128 v[80:83], v11 offset:16384
  s_waitcnt lgkmcnt(14)
  ds_read_b64_tr_b16 v[112:113], v9 offset:16384
  s_waitcnt lgkmcnt(14)
  ds_read_b64_tr_b16 v[114:115], v9 offset:17408
  s_waitcnt lgkmcnt(14)
  v_mfma_f32_32x32x16_bf16 v[32:47], v[96:99], v[64:67], v[32:47]
  ds_read_b128 v[84:87], v11 offset:17408
  s_waitcnt lgkmcnt(14)
  ds_read_b64_tr_b16 v[116:117], v9 offset:18432
  s_waitcnt lgkmcnt(14)
  ds_read_b64_tr_b16 v[118:119], v9 offset:19456
  s_waitcnt lgkmcnt(11)
  v_mfma_f32_32x32x16_bf16 v[32:47], v[100:103], v[68:71], v[32:47]
  s_waitcnt vmcnt(3)
  s_add_u32 s16, s8, 0x1706000
  buffer_store_dword v19, v20, s[60:63], s16 offen sc1
  ds_read_b128 v[88:91], v11 offset:18432
  ds_read_b64_tr_b16 v[120:121], v9 offset:20480
  ds_read_b64_tr_b16 v[122:123], v9 offset:21504
  v_mfma_f32_32x32x16_bf16 v[32:47], v[104:107], v[72:75], v[32:47]
  ds_read_b128 v[92:95], v11 offset:19456
  s_waitcnt lgkmcnt(14)
  ds_read_b64_tr_b16 v[124:125], v9 offset:22528
  s_waitcnt lgkmcnt(14)
  ds_read_b64_tr_b16 v[126:127], v9 offset:23552
  s_waitcnt lgkmcnt(9)
  v_mfma_f32_32x32x16_bf16 v[32:47], v[108:111], v[76:79], v[32:47]
  v_mfma_f32_32x32x16_bf16 v[32:47], v[112:115], v[80:83], v[32:47]
  s_waitcnt lgkmcnt(3)
  v_mfma_f32_32x32x16_bf16 v[32:47], v[116:119], v[84:87], v[32:47]
  s_waitcnt lgkmcnt(0)
  s_barrier
  ds_read_b128 v[64:67], v11 offset:32768
  ds_read_b64_tr_b16 v[96:97], v9 offset:32768
  ds_read_b64_tr_b16 v[98:99], v9 offset:33792
  ds_read_b128 v[68:71], v11 offset:33792
  ds_read_b64_tr_b16 v[100:101], v9 offset:34816
  ds_read_b64_tr_b16 v[102:103], v9 offset:35840
  ds_read_b128 v[72:75], v11 offset:34816
  ds_read_b64_tr_b16 v[104:105], v9 offset:36864
  ds_read_b64_tr_b16 v[106:107], v9 offset:37888
  v_mfma_f32_32x32x16_bf16 v[32:47], v[120:123], v[88:91], v[32:47]
  ds_read_b128 v[76:79], v11 offset:35840
  ds_read_b64_tr_b16 v[108:109], v9 offset:38912
  ds_read_b64_tr_b16 v[110:111], v9 offset:39936
  v_mfma_f32_32x32x16_bf16 v[32:47], v[124:127], v[92:95], v[32:47]
  ds_read_b128 v[80:83], v11 offset:49152
  ds_read_b64_tr_b16 v[112:113], v9 offset:49152
  ds_read_b64_tr_b16 v[114:115], v9 offset:50176
  s_waitcnt lgkmcnt(12)
  v_mfma_f32_32x32x16_bf16 v[32:47], v[96:99], v[64:67], v[32:47]
  ds_read_b128 v[84:87], v11 offset:50176
  ds_read_b64_tr_b16 v[116:117], v9 offset:51200
  ds_read_b64_tr_b16 v[118:119], v9 offset:52224
  s_waitcnt lgkmcnt(9)
  v_mfma_f32_32x32x16_bf16 v[32:47], v[100:103], v[68:71], v[32:47]
  ds_read_b128 v[88:91], v11 offset:51200
  ds_read_b64_tr_b16 v[120:121], v9 offset:53248
  ds_read_b64_tr_b16 v[122:123], v9 offset:54272
  v_mfma_f32_32x32x16_bf16 v[32:47], v[104:107], v[72:75], v[32:47]
  s_waitcnt vmcnt(1)
  v_mfma_f32_32x32x16_bf16 v[144:159], v[128:131], v[136:139], 0
  v_mfma_f32_32x32x16_bf16 v[160:175], v[132:135], v[140:143], 0
  ds_read_b128 v[92:95], v11 offset:52224
  ds_read_b64_tr_b16 v[124:125], v9 offset:55296
  ds_read_b64_tr_b16 v[126:127], v9 offset:56320
  s_waitcnt lgkmcnt(9)
  v_mfma_f32_32x32x16_bf16 v[32:47], v[108:111], v[76:79], v[32:47]
  v_mfma_f32_32x32x16_bf16 v[32:47], v[112:115], v[80:83], v[32:47]
  s_nop 4
  v_add_f32 v152, s13, v152
  v_add_f32 v160, s13, v160
  v_rcp_f32 v152, v152
  v_rcp_f32 v160, v160
  v_mul_f32 v144, v144, v152
  v_mul_f32 v145, v145, v152
  v_mul_f32 v146, v146, v152
  v_mul_f32 v147, v147, v152
  v_mul_f32 v148, v148, v152
  v_mul_f32 v149, v149, v152
  v_mul_f32 v150, v150, v152
  v_mul_f32 v151, v151, v152
  v_mul_f32 v168, v168, v160
  v_mul_f32 v169, v169, v160
  s_waitcnt lgkmcnt(3)
  v_mfma_f32_32x32x16_bf16 v[32:47], v[116:119], v[84:87], v[32:47]
  v_mul_f32 v170, v170, v160
  v_mul_f32 v171, v171, v160
  v_mul_f32 v172, v172, v160
  v_mul_f32 v173, v173, v160
  v_mul_f32 v174, v174, v160
  v_mul_f32 v175, v175, v160
  v_cvt_pk_bf16_f32 v128, v144, v145
  v_cvt_pk_bf16_f32 v129, v146, v147
  v_cvt_pk_bf16_f32 v130, v148, v149
  v_cvt_pk_bf16_f32 v131, v150, v151
  v_cvt_pk_bf16_f32 v132, v168, v169
  v_cvt_pk_bf16_f32 v133, v170, v171
  v_cvt_pk_bf16_f32 v134, v172, v173
  v_cvt_pk_bf16_f32 v135, v174, v175
  s_add_u32 s72, s7, 0x600000
  buffer_store_dwordx4 v[128:131], v21, s[60:63], s72 offen sc1
  buffer_store_dwordx4 v[132:135], v21, s[60:63], s72 offen offset:1024 sc1
  s_waitcnt lgkmcnt(0)
  s_barrier
  ds_read_b128 v[64:67], v10 offset:0
  ds_read_b64_tr_b16 v[96:97], v8 offset:0
  ds_read_b64_tr_b16 v[98:99], v8 offset:1024
  ds_read_b128 v[68:71], v10 offset:1024
  ds_read_b64_tr_b16 v[100:101], v8 offset:2048
  ds_read_b64_tr_b16 v[102:103], v8 offset:3072
  ds_read_b128 v[72:75], v10 offset:2048
  ds_read_b64_tr_b16 v[104:105], v8 offset:4096
  ds_read_b64_tr_b16 v[106:107], v8 offset:5120
  v_mfma_f32_32x32x16_bf16 v[32:47], v[120:123], v[88:91], v[32:47]
  ds_read_b128 v[76:79], v10 offset:3072
  ds_read_b64_tr_b16 v[108:109], v8 offset:6144
  ds_read_b64_tr_b16 v[110:111], v8 offset:7168
  v_mfma_f32_32x32x16_bf16 v[32:47], v[124:127], v[92:95], v[32:47]
  ds_read_b128 v[80:83], v10 offset:16384
  ds_read_b64_tr_b16 v[112:113], v8 offset:16384
  ds_read_b64_tr_b16 v[114:115], v8 offset:17408
  s_waitcnt lgkmcnt(12)
  v_mfma_f32_32x32x16_bf16 v[32:47], v[96:99], v[64:67], v[32:47]
  ds_read_b128 v[84:87], v10 offset:17408
  ds_read_b64_tr_b16 v[116:117], v8 offset:18432
  ds_read_b64_tr_b16 v[118:119], v8 offset:19456
  s_waitcnt lgkmcnt(9)
  v_mfma_f32_32x32x16_bf16 v[32:47], v[100:103], v[68:71], v[32:47]
  ds_read_b128 v[88:91], v10 offset:18432
  ds_read_b64_tr_b16 v[120:121], v8 offset:20480
  ds_read_b64_tr_b16 v[122:123], v8 offset:21504
  v_mfma_f32_32x32x16_bf16 v[32:47], v[104:107], v[72:75], v[32:47]
  ds_read_b128 v[92:95], v10 offset:19456
  ds_read_b64_tr_b16 v[124:125], v8 offset:22528
  ds_read_b64_tr_b16 v[126:127], v8 offset:23552
  s_waitcnt lgkmcnt(9)
  v_mfma_f32_32x32x16_bf16 v[32:47], v[108:111], v[76:79], v[32:47]
  v_mfma_f32_32x32x16_bf16 v[32:47], v[112:115], v[80:83], v[32:47]
  s_waitcnt lgkmcnt(3)
  v_mfma_f32_32x32x16_bf16 v[32:47], v[116:119], v[84:87], v[32:47]
  s_waitcnt lgkmcnt(0)
  s_barrier
  ds_read_b128 v[64:67], v10 offset:32768
  ds_read_b64_tr_b16 v[96:97], v8 offset:32768
  ds_read_b64_tr_b16 v[98:99], v8 offset:33792
  ds_read_b128 v[68:71], v10 offset:33792
  ds_read_b64_tr_b16 v[100:101], v8 offset:34816
  ds_read_b64_tr_b16 v[102:103], v8 offset:35840
  ds_read_b128 v[72:75], v10 offset:34816
  ds_read_b64_tr_b16 v[104:105], v8 offset:36864
  ds_read_b64_tr_b16 v[106:107], v8 offset:37888
  v_mfma_f32_32x32x16_bf16 v[32:47], v[120:123], v[88:91], v[32:47]
  ds_read_b128 v[76:79], v10 offset:35840
  ds_read_b64_tr_b16 v[108:109], v8 offset:38912
  ds_read_b64_tr_b16 v[110:111], v8 offset:39936
  v_mfma_f32_32x32x16_bf16 v[32:47], v[124:127], v[92:95], v[32:47]
  ds_read_b128 v[80:83], v10 offset:49152
  ds_read_b64_tr_b16 v[112:113], v8 offset:49152
  ds_read_b64_tr_b16 v[114:115], v8 offset:50176
  s_waitcnt lgkmcnt(12)
  v_mfma_f32_32x32x16_bf16 v[32:47], v[96:99], v[64:67], v[32:47]
  ds_read_b128 v[84:87], v10 offset:50176
  ds_read_b64_tr_b16 v[116:117], v8 offset:51200
  ds_read_b64_tr_b16 v[118:119], v8 offset:52224
  s_waitcnt lgkmcnt(9)
  v_mfma_f32_32x32x16_bf16 v[32:47], v[100:103], v[68:71], v[32:47]
  ds_read_b128 v[88:91], v10 offset:51200
  ds_read_b64_tr_b16 v[120:121], v8 offset:53248
  ds_read_b64_tr_b16 v[122:123], v8 offset:54272
  v_mfma_f32_32x32x16_bf16 v[32:47], v[104:107], v[72:75], v[32:47]
  s_waitcnt vmcnt(0)
  s_add_u32 s16, s8, 0x1707000
  buffer_store_dword v19, v20, s[60:63], s16 offen sc1
  ds_read_b128 v[92:95], v10 offset:52224
  ds_read_b64_tr_b16 v[124:125], v8 offset:55296
  ds_read_b64_tr_b16 v[126:127], v8 offset:56320
  s_waitcnt lgkmcnt(9)
  v_mfma_f32_32x32x16_bf16 v[32:47], v[108:111], v[76:79], v[32:47]
  v_mfma_f32_32x32x16_bf16 v[32:47], v[112:115], v[80:83], v[32:47]
  s_waitcnt lgkmcnt(3)
  v_mfma_f32_32x32x16_bf16 v[32:47], v[116:119], v[84:87], v[32:47]
  s_waitcnt lgkmcnt(0)
  s_barrier
  ds_read_b128 v[64:67], v11 offset:0
  ds_read_b64_tr_b16 v[96:97], v9 offset:0
  ds_read_b64_tr_b16 v[98:99], v9 offset:1024
  ds_read_b128 v[68:71], v11 offset:1024
  ds_read_b64_tr_b16 v[100:101], v9 offset:2048
  ds_read_b64_tr_b16 v[102:103], v9 offset:3072
  ds_read_b128 v[72:75], v11 offset:2048
  ds_read_b64_tr_b16 v[104:105], v9 offset:4096
  ds_read_b64_tr_b16 v[106:107], v9 offset:5120
  v_mfma_f32_32x32x16_bf16 v[32:47], v[120:123], v[88:91], v[32:47]
  ds_read_b128 v[76:79], v11 offset:3072
  ds_read_b64_tr_b16 v[108:109], v9 offset:6144
  ds_read_b64_tr_b16 v[110:111], v9 offset:7168
  v_mfma_f32_32x32x16_bf16 v[32:47], v[124:127], v[92:95], v[32:47]
  ds_read_b128 v[80:83], v11 offset:16384
  ds_read_b64_tr_b16 v[112:113], v9 offset:16384
  ds_read_b64_tr_b16 v[114:115], v9 offset:17408
  s_waitcnt lgkmcnt(12)
  v_mfma_f32_32x32x16_bf16 v[32:47], v[96:99], v[64:67], v[32:47]
  ds_read_b128 v[84:87], v11 offset:17408
  ds_read_b64_tr_b16 v[116:117], v9 offset:18432
  ds_read_b64_tr_b16 v[118:119], v9 offset:19456
  s_waitcnt lgkmcnt(9)
  v_mfma_f32_32x32x16_bf16 v[32:47], v[100:103], v[68:71], v[32:47]
  ds_read_b128 v[88:91], v11 offset:18432
  ds_read_b64_tr_b16 v[120:121], v9 offset:20480
  ds_read_b64_tr_b16 v[122:123], v9 offset:21504
  v_mfma_f32_32x32x16_bf16 v[32:47], v[104:107], v[72:75], v[32:47]
  ds_read_b128 v[92:95], v11 offset:19456
  ds_read_b64_tr_b16 v[124:125], v9 offset:22528
  ds_read_b64_tr_b16 v[126:127], v9 offset:23552
  s_waitcnt lgkmcnt(9)
  v_mfma_f32_32x32x16_bf16 v[32:47], v[108:111], v[76:79], v[32:47]
  v_mfma_f32_32x32x16_bf16 v[32:47], v[112:115], v[80:83], v[32:47]
  s_waitcnt lgkmcnt(3)
  v_mfma_f32_32x32x16_bf16 v[32:47], v[116:119], v[84:87], v[32:47]
  s_waitcnt lgkmcnt(0)
  s_barrier
  ds_read_b128 v[64:67], v11 offset:32768
  ds_read_b64_tr_b16 v[96:97], v9 offset:32768
  ds_read_b64_tr_b16 v[98:99], v9 offset:33792
  ds_read_b128 v[68:71], v11 offset:33792
  ds_read_b64_tr_b16 v[100:101], v9 offset:34816
  ds_read_b64_tr_b16 v[102:103], v9 offset:35840
  ds_read_b128 v[72:75], v11 offset:34816
  ds_read_b64_tr_b16 v[104:105], v9 offset:36864
  ds_read_b64_tr_b16 v[106:107], v9 offset:37888
  v_mfma_f32_32x32x16_bf16 v[32:47], v[120:123], v[88:91], v[32:47]
  ds_read_b128 v[76:79], v11 offset:35840
  ds_read_b64_tr_b16 v[108:109], v9 offset:38912
  ds_read_b64_tr_b16 v[110:111], v9 offset:39936
  v_mfma_f32_32x32x16_bf16 v[32:47], v[124:127], v[92:95], v[32:47]
  ds_read_b128 v[80:83], v11 offset:49152
  ds_read_b64_tr_b16 v[112:113], v9 offset:49152
  ds_read_b64_tr_b16 v[114:115], v9 offset:50176
  s_waitcnt lgkmcnt(12)
  v_mfma_f32_32x32x16_bf16 v[32:47], v[96:99], v[64:67], v[32:47]
  ds_read_b128 v[84:87], v11 offset:50176
  ds_read_b64_tr_b16 v[116:117], v9 offset:51200
  ds_read_b64_tr_b16 v[118:119], v9 offset:52224
  s_waitcnt lgkmcnt(9)
  v_mfma_f32_32x32x16_bf16 v[32:47], v[100:103], v[68:71], v[32:47]
  ds_read_b128 v[88:91], v11 offset:51200
  ds_read_b64_tr_b16 v[120:121], v9 offset:53248
  ds_read_b64_tr_b16 v[122:123], v9 offset:54272
  v_mfma_f32_32x32x16_bf16 v[32:47], v[104:107], v[72:75], v[32:47]
  ds_read_b128 v[92:95], v11 offset:52224
  ds_read_b64_tr_b16 v[124:125], v9 offset:55296
  ds_read_b64_tr_b16 v[126:127], v9 offset:56320
  s_waitcnt lgkmcnt(9)
  v_mfma_f32_32x32x16_bf16 v[32:47], v[108:111], v[76:79], v[32:47]
  v_mfma_f32_32x32x16_bf16 v[32:47], v[112:115], v[80:83], v[32:47]
  s_waitcnt lgkmcnt(3)
  v_mfma_f32_32x32x16_bf16 v[32:47], v[116:119], v[84:87], v[32:47]
  s_waitcnt lgkmcnt(0)
  s_barrier
  ds_read_b128 v[64:67], v10 offset:0
  ds_read_b64_tr_b16 v[96:97], v8 offset:0
  ds_read_b64_tr_b16 v[98:99], v8 offset:1024
  ds_read_b128 v[68:71], v10 offset:1024
  ds_read_b64_tr_b16 v[100:101], v8 offset:2048
  ds_read_b64_tr_b16 v[102:103], v8 offset:3072
  ds_read_b128 v[72:75], v10 offset:2048
  ds_read_b64_tr_b16 v[104:105], v8 offset:4096
  ds_read_b64_tr_b16 v[106:107], v8 offset:5120
  v_mfma_f32_32x32x16_bf16 v[32:47], v[120:123], v[88:91], v[32:47]
  ds_read_b128 v[76:79], v10 offset:3072
  ds_read_b64_tr_b16 v[108:109], v8 offset:6144
  ds_read_b64_tr_b16 v[110:111], v8 offset:7168
  v_mfma_f32_32x32x16_bf16 v[32:47], v[124:127], v[92:95], v[32:47]
  ds_read_b128 v[80:83], v10 offset:16384
  ds_read_b64_tr_b16 v[112:113], v8 offset:16384
  ds_read_b64_tr_b16 v[114:115], v8 offset:17408
  s_waitcnt lgkmcnt(12)
  v_mfma_f32_32x32x16_bf16 v[32:47], v[96:99], v[64:67], v[32:47]
  ds_read_b128 v[84:87], v10 offset:17408
  ds_read_b64_tr_b16 v[116:117], v8 offset:18432
  ds_read_b64_tr_b16 v[118:119], v8 offset:19456
  s_waitcnt lgkmcnt(9)
  v_mfma_f32_32x32x16_bf16 v[32:47], v[100:103], v[68:71], v[32:47]
  ds_read_b128 v[88:91], v10 offset:18432
  ds_read_b64_tr_b16 v[120:121], v8 offset:20480
  ds_read_b64_tr_b16 v[122:123], v8 offset:21504
  v_mfma_f32_32x32x16_bf16 v[32:47], v[104:107], v[72:75], v[32:47]
  ds_read_b128 v[92:95], v10 offset:19456
  ds_read_b64_tr_b16 v[124:125], v8 offset:22528
  ds_read_b64_tr_b16 v[126:127], v8 offset:23552
  s_waitcnt lgkmcnt(9)
  v_mfma_f32_32x32x16_bf16 v[32:47], v[108:111], v[76:79], v[32:47]
  v_mfma_f32_32x32x16_bf16 v[32:47], v[112:115], v[80:83], v[32:47]
  s_waitcnt lgkmcnt(3)
  v_mfma_f32_32x32x16_bf16 v[32:47], v[116:119], v[84:87], v[32:47]
  s_waitcnt lgkmcnt(0)
  s_barrier
  ds_read_b128 v[64:67], v10 offset:32768
  ds_read_b64_tr_b16 v[96:97], v8 offset:32768
  ds_read_b64_tr_b16 v[98:99], v8 offset:33792
  ds_read_b128 v[68:71], v10 offset:33792
  ds_read_b64_tr_b16 v[100:101], v8 offset:34816
  ds_read_b64_tr_b16 v[102:103], v8 offset:35840
  ds_read_b128 v[72:75], v10 offset:34816
  ds_read_b64_tr_b16 v[104:105], v8 offset:36864
  ds_read_b64_tr_b16 v[106:107], v8 offset:37888
  v_mfma_f32_32x32x16_bf16 v[32:47], v[120:123], v[88:91], v[32:47]
  ds_read_b128 v[76:79], v10 offset:35840
  ds_read_b64_tr_b16 v[108:109], v8 offset:38912
  ds_read_b64_tr_b16 v[110:111], v8 offset:39936
  v_mfma_f32_32x32x16_bf16 v[32:47], v[124:127], v[92:95], v[32:47]
  ds_read_b128 v[80:83], v10 offset:49152
  ds_read_b64_tr_b16 v[112:113], v8 offset:49152
  ds_read_b64_tr_b16 v[114:115], v8 offset:50176
  s_waitcnt lgkmcnt(12)
  v_mfma_f32_32x32x16_bf16 v[32:47], v[96:99], v[64:67], v[32:47]
  ds_read_b128 v[84:87], v10 offset:50176
  ds_read_b64_tr_b16 v[116:117], v8 offset:51200
  ds_read_b64_tr_b16 v[118:119], v8 offset:52224
  s_waitcnt lgkmcnt(9)
  v_mfma_f32_32x32x16_bf16 v[32:47], v[100:103], v[68:71], v[32:47]
  ds_read_b128 v[88:91], v10 offset:51200
  ds_read_b64_tr_b16 v[120:121], v8 offset:53248
  ds_read_b64_tr_b16 v[122:123], v8 offset:54272
  v_mfma_f32_32x32x16_bf16 v[32:47], v[104:107], v[72:75], v[32:47]
  ds_read_b128 v[92:95], v10 offset:52224
  ds_read_b64_tr_b16 v[124:125], v8 offset:55296
  ds_read_b64_tr_b16 v[126:127], v8 offset:56320
  s_waitcnt lgkmcnt(9)
  v_mfma_f32_32x32x16_bf16 v[32:47], v[108:111], v[76:79], v[32:47]
  v_mfma_f32_32x32x16_bf16 v[32:47], v[112:115], v[80:83], v[32:47]
  s_waitcnt lgkmcnt(3)
  v_mfma_f32_32x32x16_bf16 v[32:47], v[116:119], v[84:87], v[32:47]
  s_waitcnt lgkmcnt(0)
  s_barrier
  ds_read_b128 v[64:67], v11 offset:0
  ds_read_b64_tr_b16 v[96:97], v9 offset:0
  ds_read_b64_tr_b16 v[98:99], v9 offset:1024
  ds_read_b128 v[68:71], v11 offset:1024
  ds_read_b64_tr_b16 v[100:101], v9 offset:2048
  ds_read_b64_tr_b16 v[102:103], v9 offset:3072
  ds_read_b128 v[72:75], v11 offset:2048
  ds_read_b64_tr_b16 v[104:105], v9 offset:4096
  ds_read_b64_tr_b16 v[106:107], v9 offset:5120
  v_mfma_f32_32x32x16_bf16 v[32:47], v[120:123], v[88:91], v[32:47]
  ds_read_b128 v[76:79], v11 offset:3072
  ds_read_b64_tr_b16 v[108:109], v9 offset:6144
  ds_read_b64_tr_b16 v[110:111], v9 offset:7168
  v_mfma_f32_32x32x16_bf16 v[32:47], v[124:127], v[92:95], v[32:47]
  ds_read_b128 v[80:83], v11 offset:16384
  ds_read_b64_tr_b16 v[112:113], v9 offset:16384
  ds_read_b64_tr_b16 v[114:115], v9 offset:17408
  s_waitcnt lgkmcnt(12)
  v_mfma_f32_32x32x16_bf16 v[32:47], v[96:99], v[64:67], v[32:47]
  ds_read_b64 v[208:209], v18
  v_xor_b32 v31, 16, v18
  ds_read_b128 v[84:87], v11 offset:17408
  ds_read_b64_tr_b16 v[116:117], v9 offset:18432
  s_waitcnt lgkmcnt(14)
  ds_read_b64_tr_b16 v[118:119], v9 offset:19456
  s_waitcnt lgkmcnt(10)
  v_mfma_f32_32x32x16_bf16 v[32:47], v[100:103], v[68:71], v[32:47]
  ds_read_b64 v[210:211], v31
  v_xor_b32 v31, 32, v18
  ds_read_b128 v[88:91], v11 offset:18432
  ds_read_b64_tr_b16 v[120:121], v9 offset:20480
  ds_read_b64_tr_b16 v[122:123], v9 offset:21504
  v_mfma_f32_32x32x16_bf16 v[32:47], v[104:107], v[72:75], v[32:47]
  ds_read_b64 v[212:213], v31
  v_xor_b32 v31, 48, v18
  s_waitcnt lgkmcnt(14)
  ds_read_b64 v[214:215], v31
  s_waitcnt lgkmcnt(14)
  ds_read_b128 v[92:95], v11 offset:19456
  s_waitcnt lgkmcnt(14)
  ds_read_b64_tr_b16 v[124:125], v9 offset:22528
  s_waitcnt lgkmcnt(14)
  ds_read_b64_tr_b16 v[126:127], v9 offset:23552
  v_mfma_f32_32x32x16_bf16 v[32:47], v[108:111], v[76:79], v[32:47]
  v_lshlrev_b32 v192, 16, v22
  v_and_b32 v193, 0xffff0000, v22
  s_waitcnt lgkmcnt(9)
  v_mfma_f32_32x32x16_bf16 v[32:47], v[112:115], v[80:83], v[32:47]
  v_lshlrev_b32 v194, 16, v23
  v_and_b32 v195, 0xffff0000, v23
  v_mfma_f32_32x32x16_bf16 v[32:47], v[116:119], v[84:87], v[32:47]
  v_lshlrev_b32 v196, 16, v24
  v_and_b32 v197, 0xffff0000, v24
  s_waitcnt lgkmcnt(0)
  s_barrier
  ds_read_b128 v[64:67], v11 offset:32768
  ds_read_b64_tr_b16 v[96:97], v9 offset:32768
  ds_read_b64_tr_b16 v[98:99], v9 offset:33792
  ds_read_b128 v[68:71], v11 offset:33792
  ds_read_b64_tr_b16 v[100:101], v9 offset:34816
  ds_read_b64_tr_b16 v[102:103], v9 offset:35840
  ds_read_b128 v[72:75], v11 offset:34816
  ds_read_b64_tr_b16 v[104:105], v9 offset:36864
  ds_read_b64_tr_b16 v[106:107], v9 offset:37888
  v_mfma_f32_32x32x16_bf16 v[32:47], v[120:123], v[88:91], v[32:47]
  v_lshlrev_b32 v198, 16, v25
  v_and_b32 v199, 0xffff0000, v25
  ds_read_b128 v[76:79], v11 offset:35840
  ds_read_b64_tr_b16 v[108:109], v9 offset:38912
  ds_read_b64_tr_b16 v[110:111], v9 offset:39936
  v_mfma_f32_32x32x16_bf16 v[32:47], v[124:127], v[92:95], v[32:47]
  v_lshlrev_b32 v200, 16, v26
  v_and_b32 v201, 0xffff0000, v26
  v_lshlrev_b32 v202, 16, v27
  ds_read_b128 v[80:83], v11 offset:49152
  ds_read_b64_tr_b16 v[112:113], v9 offset:49152
  ds_read_b64_tr_b16 v[114:115], v9 offset:50176
  s_waitcnt lgkmcnt(12)
  v_mfma_f32_32x32x16_bf16 v[32:47], v[96:99], v[64:67], v[32:47]
  v_and_b32 v203, 0xffff0000, v27
  v_lshlrev_b32 v204, 16, v28
  ds_read_b128 v[84:87], v11 offset:50176
  ds_read_b64_tr_b16 v[116:117], v9 offset:51200
  ds_read_b64_tr_b16 v[118:119], v9 offset:52224
  s_waitcnt lgkmcnt(9)
  v_mfma_f32_32x32x16_bf16 v[32:47], v[100:103], v[68:71], v[32:47]
  v_and_b32 v205, 0xffff0000, v28
  v_lshlrev_b32 v206, 16, v29
  ds_read_b128 v[88:91], v11 offset:51200
  ds_read_b64_tr_b16 v[120:121], v9 offset:53248
  ds_read_b64_tr_b16 v[122:123], v9 offset:54272
  v_mfma_f32_32x32x16_bf16 v[32:47], v[104:107], v[72:75], v[32:47]
  v_and_b32 v207, 0xffff0000, v29
  v_lshlrev_b32 v176, 16, v208
  ds_read_b128 v[92:95], v11 offset:52224
  ds_read_b64_tr_b16 v[124:125], v9 offset:55296
  ds_read_b64_tr_b16 v[126:127], v9 offset:56320
  s_waitcnt lgkmcnt(9)
  v_mfma_f32_32x32x16_bf16 v[32:47], v[108:111], v[76:79], v[32:47]
  v_and_b32 v177, 0xffff0000, v208
  v_lshlrev_b32 v178, 16, v209
  v_mfma_f32_32x32x16_bf16 v[32:47], v[112:115], v[80:83], v[32:47]
  v_and_b32 v179, 0xffff0000, v209
  v_lshlrev_b32 v180, 16, v210
  v_and_b32 v181, 0xffff0000, v210
  s_waitcnt lgkmcnt(3)
  v_mfma_f32_32x32x16_bf16 v[32:47], v[116:119], v[84:87], v[32:47]
  v_lshlrev_b32 v182, 16, v211
  v_and_b32 v183, 0xffff0000, v211
  s_waitcnt lgkmcnt(0)
  s_barrier
  ds_read_b128 v[64:67], v10 offset:0
  ds_read_b64_tr_b16 v[96:97], v8 offset:0
  ds_read_b64_tr_b16 v[98:99], v8 offset:1024
  ds_read_b128 v[68:71], v10 offset:1024
  ds_read_b64_tr_b16 v[100:101], v8 offset:2048
  ds_read_b64_tr_b16 v[102:103], v8 offset:3072
  ds_read_b128 v[72:75], v10 offset:2048
  ds_read_b64_tr_b16 v[104:105], v8 offset:4096
  ds_read_b64_tr_b16 v[106:107], v8 offset:5120
  v_mfma_f32_32x32x16_bf16 v[32:47], v[120:123], v[88:91], v[32:47]
  v_lshlrev_b32 v184, 16, v212
  v_and_b32 v185, 0xffff0000, v212
  ds_read_b128 v[76:79], v10 offset:3072
  ds_read_b64_tr_b16 v[108:109], v8 offset:6144
  ds_read_b64_tr_b16 v[110:111], v8 offset:7168
  v_mfma_f32_32x32x16_bf16 v[32:47], v[124:127], v[92:95], v[32:47]
  v_lshlrev_b32 v186, 16, v213
  v_and_b32 v187, 0xffff0000, v213
  ds_read_b128 v[80:83], v10 offset:16384
  ds_read_b64_tr_b16 v[112:113], v8 offset:16384
  ds_read_b64_tr_b16 v[114:115], v8 offset:17408
  s_waitcnt lgkmcnt(12)
  v_mfma_f32_32x32x16_bf16 v[32:47], v[96:99], v[64:67], v[32:47]
  v_lshlrev_b32 v188, 16, v214
  v_and_b32 v189, 0xffff0000, v214
  ds_read_b128 v[84:87], v10 offset:17408
  ds_read_b64_tr_b16 v[116:117], v8 offset:18432
  ds_read_b64_tr_b16 v[118:119], v8 offset:19456
  s_waitcnt lgkmcnt(9)
  v_mfma_f32_32x32x16_bf16 v[32:47], v[100:103], v[68:71], v[32:47]
  v_lshlrev_b32 v190, 16, v215
  v_and_b32 v191, 0xffff0000, v215
  s_lshl_b32 s72, s6, 15
  ds_read_b128 v[88:91], v10 offset:18432
  ds_read_b64_tr_b16 v[120:121], v8 offset:20480
  ds_read_b64_tr_b16 v[122:123], v8 offset:21504
  v_mfma_f32_32x32x16_bf16 v[32:47], v[104:107], v[72:75], v[32:47]
  s_lshl_b32 s73, s4, 5
  s_add_u32 s72, s72, s73
  ds_read_b128 v[92:95], v10 offset:19456
  ds_read_b64_tr_b16 v[124:125], v8 offset:22528
  ds_read_b64_tr_b16 v[126:127], v8 offset:23552
  s_waitcnt lgkmcnt(9)
  v_mfma_f32_32x32x16_bf16 v[32:47], v[108:111], v[76:79], v[32:47]
  v_lshl_add_u32 v12, v1, 10, s72
  v_lshl_add_u32 v12, v2, 3, v12
  v_mfma_f32_32x32x16_bf16 v[32:47], v[112:115], v[80:83], v[32:47]
  s_waitcnt lgkmcnt(3)
  v_mfma_f32_32x32x16_bf16 v[32:47], v[116:119], v[84:87], v[32:47]
  s_waitcnt lgkmcnt(0)
  s_barrier
  ds_read_b128 v[64:67], v10 offset:32768
  ds_read_b64_tr_b16 v[96:97], v8 offset:32768
  ds_read_b64_tr_b16 v[98:99], v8 offset:33792
  ds_read_b128 v[68:71], v10 offset:33792
  ds_read_b64_tr_b16 v[100:101], v8 offset:34816
  ds_read_b64_tr_b16 v[102:103], v8 offset:35840
  ds_read_b128 v[72:75], v10 offset:34816
  ds_read_b64_tr_b16 v[104:105], v8 offset:36864
  ds_read_b64_tr_b16 v[106:107], v8 offset:37888
  v_mfma_f32_32x32x16_bf16 v[32:47], v[120:123], v[88:91], v[32:47]
  ds_read_b128 v[76:79], v10 offset:35840
  ds_read_b64_tr_b16 v[108:109], v8 offset:38912
  ds_read_b64_tr_b16 v[110:111], v8 offset:39936
  v_mfma_f32_32x32x16_bf16 v[32:47], v[124:127], v[92:95], v[32:47]
  ds_read_b128 v[80:83], v10 offset:49152
  ds_read_b64_tr_b16 v[112:113], v8 offset:49152
  ds_read_b64_tr_b16 v[114:115], v8 offset:50176
  s_waitcnt lgkmcnt(12)
  v_mfma_f32_32x32x16_bf16 v[32:47], v[96:99], v[64:67], v[32:47]
  ds_read_b128 v[84:87], v10 offset:50176
  ds_read_b64_tr_b16 v[116:117], v8 offset:51200
  ds_read_b64_tr_b16 v[118:119], v8 offset:52224
  s_waitcnt lgkmcnt(9)
  v_mfma_f32_32x32x16_bf16 v[32:47], v[100:103], v[68:71], v[32:47]
  ds_read_b128 v[88:91], v10 offset:51200
  ds_read_b64_tr_b16 v[120:121], v8 offset:53248
  ds_read_b64_tr_b16 v[122:123], v8 offset:54272
  v_mfma_f32_32x32x16_bf16 v[32:47], v[104:107], v[72:75], v[32:47]
  ds_read_b128 v[92:95], v10 offset:52224
  ds_read_b64_tr_b16 v[124:125], v8 offset:55296
  ds_read_b64_tr_b16 v[126:127], v8 offset:56320
  s_waitcnt lgkmcnt(9)
  v_mfma_f32_32x32x16_bf16 v[32:47], v[108:111], v[76:79], v[32:47]
  v_mfma_f32_32x32x16_bf16 v[32:47], v[112:115], v[80:83], v[32:47]
  s_waitcnt lgkmcnt(3)
  v_mfma_f32_32x32x16_bf16 v[32:47], v[116:119], v[84:87], v[32:47]
  s_waitcnt lgkmcnt(0)
  s_barrier
  ds_read_b128 v[64:67], v11 offset:0
  ds_read_b64_tr_b16 v[96:97], v9 offset:0
  ds_read_b64_tr_b16 v[98:99], v9 offset:1024
  ds_read_b128 v[68:71], v11 offset:1024
  ds_read_b64_tr_b16 v[100:101], v9 offset:2048
  ds_read_b64_tr_b16 v[102:103], v9 offset:3072
  ds_read_b128 v[72:75], v11 offset:2048
  ds_read_b64_tr_b16 v[104:105], v9 offset:4096
  ds_read_b64_tr_b16 v[106:107], v9 offset:5120
  v_mfma_f32_32x32x16_bf16 v[32:47], v[120:123], v[88:91], v[32:47]
  ds_read_b128 v[76:79], v11 offset:3072
  ds_read_b64_tr_b16 v[108:109], v9 offset:6144
  ds_read_b64_tr_b16 v[110:111], v9 offset:7168
  v_mfma_f32_32x32x16_bf16 v[32:47], v[124:127], v[92:95], v[32:47]
  ds_read_b128 v[80:83], v11 offset:16384
  ds_read_b64_tr_b16 v[112:113], v9 offset:16384
  ds_read_b64_tr_b16 v[114:115], v9 offset:17408
  s_waitcnt lgkmcnt(12)
  v_mfma_f32_32x32x16_bf16 v[240:255], v[96:99], v[64:67], 0
  ds_read_b128 v[84:87], v11 offset:17408
  ds_read_b64_tr_b16 v[116:117], v9 offset:18432
  ds_read_b64_tr_b16 v[118:119], v9 offset:19456
  s_waitcnt lgkmcnt(9)
  v_mfma_f32_32x32x16_bf16 v[240:255], v[100:103], v[68:71], v[240:255]
  ds_read_b128 v[88:91], v11 offset:18432
  ds_read_b64_tr_b16 v[120:121], v9 offset:20480
  ds_read_b64_tr_b16 v[122:123], v9 offset:21504
  v_mfma_f32_32x32x16_bf16 v[240:255], v[104:107], v[72:75], v[240:255]
  v_add_f32 v160, v32, v192
  v_add_f32 v161, v33, v193
  v_add_f32 v162, v34, v194
  v_add_f32 v163, v35, v195
  v_add_f32 v164, v36, v196
  ds_read_b128 v[92:95], v11 offset:19456
  ds_read_b64_tr_b16 v[124:125], v9 offset:22528
  ds_read_b64_tr_b16 v[126:127], v9 offset:23552
  s_waitcnt lgkmcnt(9)
  v_mfma_f32_32x32x16_bf16 v[240:255], v[108:111], v[76:79], v[240:255]
  v_add_f32 v165, v37, v197
  v_add_f32 v166, v38, v198
  v_add_f32 v167, v39, v199
  v_add_f32 v168, v40, v200
  v_mfma_f32_32x32x16_bf16 v[240:255], v[112:115], v[80:83], v[240:255]
  v_add_f32 v169, v41, v201
  v_add_f32 v170, v42, v202
  v_add_f32 v171, v43, v203
  v_add_f32 v172, v44, v204
  v_add_f32 v173, v45, v205
  s_waitcnt lgkmcnt(3)
  v_mfma_f32_32x32x16_bf16 v[240:255], v[116:119], v[84:87], v[240:255]
  v_add_f32 v174, v46, v206
  v_add_f32 v175, v47, v207
  v_mul_f32 v128, 0xbfb8aa3b, v160
  v_mul_f32 v129, 0xbfb8aa3b, v161
  s_waitcnt lgkmcnt(0)
  s_barrier
  ds_read_b128 v[64:67], v11 offset:32768
  ds_read_b64_tr_b16 v[96:97], v9 offset:32768
  ds_read_b64_tr_b16 v[98:99], v9 offset:33792
  ds_read_b128 v[68:71], v11 offset:33792
  ds_read_b64_tr_b16 v[100:101], v9 offset:34816
  ds_read_b64_tr_b16 v[102:103], v9 offset:35840
  ds_read_b128 v[72:75], v11 offset:34816
  ds_read_b64_tr_b16 v[104:105], v9 offset:36864
  ds_read_b64_tr_b16 v[106:107], v9 offset:37888
  v_mfma_f32_32x32x16_bf16 v[240:255], v[120:123], v[88:91], v[240:255]
  v_mul_f32 v130, 0xbfb8aa3b, v162
  v_mul_f32 v131, 0xbfb8aa3b, v163
  v_mul_f32 v132, 0xbfb8aa3b, v164
  v_mul_f32 v133, 0xbfb8aa3b, v165
  v_mul_f32 v134, 0xbfb8aa3b, v166
  ds_read_b128 v[76:79], v11 offset:35840
  ds_read_b64_tr_b16 v[108:109], v9 offset:38912
  ds_read_b64_tr_b16 v[110:111], v9 offset:39936
  v_mfma_f32_32x32x16_bf16 v[240:255], v[124:127], v[92:95], v[240:255]
  v_mul_f32 v135, 0xbfb8aa3b, v167
  v_mul_f32 v136, 0xbfb8aa3b, v168
  v_mul_f32 v137, 0xbfb8aa3b, v169
  v_mul_f32 v138, 0xbfb8aa3b, v170
  ds_read_b128 v[80:83], v11 offset:49152
  ds_read_b64_tr_b16 v[112:113], v9 offset:49152
  ds_read_b64_tr_b16 v[114:115], v9 offset:50176
  s_waitcnt lgkmcnt(12)
  v_mfma_f32_32x32x16_bf16 v[240:255], v[96:99], v[64:67], v[240:255]
  v_mul_f32 v139, 0xbfb8aa3b, v171
  v_mul_f32 v140, 0xbfb8aa3b, v172
  v_mul_f32 v141, 0xbfb8aa3b, v173
  v_mul_f32 v142, 0xbfb8aa3b, v174
  v_mul_f32 v143, 0xbfb8aa3b, v175
  ds_read_b128 v[84:87], v11 offset:50176
  ds_read_b64_tr_b16 v[116:117], v9 offset:51200
  ds_read_b64_tr_b16 v[118:119], v9 offset:52224
  s_waitcnt lgkmcnt(9)
  v_mfma_f32_32x32x16_bf16 v[240:255], v[100:103], v[68:71], v[240:255]
  v_exp_f32 v128, v128
  v_exp_f32 v129, v129
  ds_read_b128 v[88:91], v11 offset:51200
  ds_read_b64_tr_b16 v[120:121], v9 offset:53248
  ds_read_b64_tr_b16 v[122:123], v9 offset:54272
  v_mfma_f32_32x32x16_bf16 v[240:255], v[104:107], v[72:75], v[240:255]
  v_exp_f32 v130, v130
  v_exp_f32 v131, v131
  v_exp_f32 v132, v132
  ds_read_b128 v[92:95], v11 offset:52224
  ds_read_b64_tr_b16 v[124:125], v9 offset:55296
  ds_read_b64_tr_b16 v[126:127], v9 offset:56320
  s_waitcnt lgkmcnt(9)
  v_mfma_f32_32x32x16_bf16 v[240:255], v[108:111], v[76:79], v[240:255]
  v_exp_f32 v133, v133
  v_exp_f32 v134, v134
  v_mfma_f32_32x32x16_bf16 v[240:255], v[112:115], v[80:83], v[240:255]
  v_exp_f32 v135, v135
  v_exp_f32 v136, v136
  s_waitcnt lgkmcnt(3)
  v_mfma_f32_32x32x16_bf16 v[240:255], v[116:119], v[84:87], v[240:255]
  v_exp_f32 v137, v137
  v_exp_f32 v138, v138
  s_waitcnt lgkmcnt(0)
  s_barrier
  ds_read_b128 v[64:67], v10 offset:0
  ds_read_b64_tr_b16 v[96:97], v8 offset:0
  ds_read_b64_tr_b16 v[98:99], v8 offset:1024
  ds_read_b128 v[68:71], v10 offset:1024
  ds_read_b64_tr_b16 v[100:101], v8 offset:2048
  ds_read_b64_tr_b16 v[102:103], v8 offset:3072
  ds_read_b128 v[72:75], v10 offset:2048
  ds_read_b64_tr_b16 v[104:105], v8 offset:4096
  ds_read_b64_tr_b16 v[106:107], v8 offset:5120
  v_mfma_f32_32x32x16_bf16 v[240:255], v[120:123], v[88:91], v[240:255]
  v_exp_f32 v139, v139
  v_exp_f32 v140, v140
  v_exp_f32 v141, v141
  ds_read_b128 v[76:79], v10 offset:3072
  ds_read_b64_tr_b16 v[108:109], v8 offset:6144
  ds_read_b64_tr_b16 v[110:111], v8 offset:7168
  v_mfma_f32_32x32x16_bf16 v[240:255], v[124:127], v[92:95], v[240:255]
  v_exp_f32 v142, v142
  v_exp_f32 v143, v143
  ds_read_b128 v[80:83], v10 offset:16384
  ds_read_b64_tr_b16 v[112:113], v8 offset:16384
  ds_read_b64_tr_b16 v[114:115], v8 offset:17408
  s_waitcnt lgkmcnt(12)
  v_mfma_f32_32x32x16_bf16 v[240:255], v[96:99], v[64:67], v[240:255]
  v_add_f32 v128, 1.0, v128
  v_add_f32 v129, 1.0, v129
  v_add_f32 v130, 1.0, v130
  v_add_f32 v131, 1.0, v131
  v_add_f32 v132, 1.0, v132
  ds_read_b128 v[84:87], v10 offset:17408
  ds_read_b64_tr_b16 v[116:117], v8 offset:18432
  ds_read_b64_tr_b16 v[118:119], v8 offset:19456
  s_waitcnt lgkmcnt(9)
  v_mfma_f32_32x32x16_bf16 v[240:255], v[100:103], v[68:71], v[240:255]
  v_add_f32 v133, 1.0, v133
  v_add_f32 v134, 1.0, v134
  v_add_f32 v135, 1.0, v135
  v_add_f32 v136, 1.0, v136
  ds_read_b128 v[88:91], v10 offset:18432
  ds_read_b64_tr_b16 v[120:121], v8 offset:20480
  ds_read_b64_tr_b16 v[122:123], v8 offset:21504
  v_mfma_f32_32x32x16_bf16 v[240:255], v[104:107], v[72:75], v[240:255]
  v_add_f32 v137, 1.0, v137
  v_add_f32 v138, 1.0, v138
  v_add_f32 v139, 1.0, v139
  v_add_f32 v140, 1.0, v140
  v_add_f32 v141, 1.0, v141
  ds_read_b128 v[92:95], v10 offset:19456
  ds_read_b64_tr_b16 v[124:125], v8 offset:22528
  ds_read_b64_tr_b16 v[126:127], v8 offset:23552
  s_waitcnt lgkmcnt(9)
  v_mfma_f32_32x32x16_bf16 v[240:255], v[108:111], v[76:79], v[240:255]
  v_add_f32 v142, 1.0, v142
  v_add_f32 v143, 1.0, v143
  v_rcp_f32 v128, v128
  v_mfma_f32_32x32x16_bf16 v[240:255], v[112:115], v[80:83], v[240:255]
  v_rcp_f32 v129, v129
  v_rcp_f32 v130, v130
  s_waitcnt lgkmcnt(3)
  v_mfma_f32_32x32x16_bf16 v[240:255], v[116:119], v[84:87], v[240:255]
  v_rcp_f32 v131, v131
  v_rcp_f32 v132, v132
  v_rcp_f32 v133, v133
  s_waitcnt lgkmcnt(0)
  s_barrier
  ds_read_b128 v[64:67], v10 offset:32768
  ds_read_b64_tr_b16 v[96:97], v8 offset:32768
  ds_read_b64_tr_b16 v[98:99], v8 offset:33792
  ds_read_b128 v[68:71], v10 offset:33792
  ds_read_b64_tr_b16 v[100:101], v8 offset:34816
  ds_read_b64_tr_b16 v[102:103], v8 offset:35840
  ds_read_b128 v[72:75], v10 offset:34816
  ds_read_b64_tr_b16 v[104:105], v8 offset:36864
  ds_read_b64_tr_b16 v[106:107], v8 offset:37888
  v_mfma_f32_32x32x16_bf16 v[240:255], v[120:123], v[88:91], v[240:255]
  v_rcp_f32 v134, v134
  v_rcp_f32 v135, v135
  ds_read_b128 v[76:79], v10 offset:35840
  ds_read_b64_tr_b16 v[108:109], v8 offset:38912
  ds_read_b64_tr_b16 v[110:111], v8 offset:39936
  v_mfma_f32_32x32x16_bf16 v[240:255], v[124:127], v[92:95], v[240:255]
  v_rcp_f32 v136, v136
  v_rcp_f32 v137, v137
  ds_read_b128 v[80:83], v10 offset:49152
  ds_read_b64_tr_b16 v[112:113], v8 offset:49152
  ds_read_b64_tr_b16 v[114:115], v8 offset:50176
  s_waitcnt lgkmcnt(12)
  v_mfma_f32_32x32x16_bf16 v[240:255], v[96:99], v[64:67], v[240:255]
  v_rcp_f32 v138, v138
  v_rcp_f32 v139, v139
  v_rcp_f32 v140, v140
  ds_read_b128 v[84:87], v10 offset:50176
  ds_read_b64_tr_b16 v[116:117], v8 offset:51200
  ds_read_b64_tr_b16 v[118:119], v8 offset:52224
  s_waitcnt lgkmcnt(9)
  v_mfma_f32_32x32x16_bf16 v[240:255], v[100:103], v[68:71], v[240:255]
  v_rcp_f32 v141, v141
  v_rcp_f32 v142, v142
  ds_read_b128 v[88:91], v10 offset:51200
  ds_read_b64_tr_b16 v[120:121], v8 offset:53248
  ds_read_b64_tr_b16 v[122:123], v8 offset:54272
  v_mfma_f32_32x32x16_bf16 v[240:255], v[104:107], v[72:75], v[240:255]
  v_rcp_f32 v143, v143
  v_mul_f32 v144, v160, v128
  v_mul_f32 v145, v161, v129
  ds_read_b128 v[92:95], v10 offset:52224
  ds_read_b64_tr_b16 v[124:125], v8 offset:55296
  ds_read_b64_tr_b16 v[126:127], v8 offset:56320
  s_waitcnt lgkmcnt(9)
  v_mfma_f32_32x32x16_bf16 v[240:255], v[108:111], v[76:79], v[240:255]
  v_mul_f32 v146, v162, v130
  v_mul_f32 v147, v163, v131
  v_mul_f32 v148, v164, v132
  v_mul_f32 v149, v165, v133
  v_mul_f32 v150, v166, v134
  v_mfma_f32_32x32x16_bf16 v[240:255], v[112:115], v[80:83], v[240:255]
  v_mul_f32 v151, v167, v135
  v_mul_f32 v152, v168, v136
  v_mul_f32 v153, v169, v137
  v_mul_f32 v154, v170, v138
  s_waitcnt lgkmcnt(3)
  v_mfma_f32_32x32x16_bf16 v[240:255], v[116:119], v[84:87], v[240:255]
  v_mul_f32 v155, v171, v139
  v_mul_f32 v156, v172, v140
  v_mul_f32 v157, v173, v141
  v_mul_f32 v158, v174, v142
  v_mul_f32 v159, v175, v143
  v_mfma_f32_32x32x16_bf16 v[240:255], v[120:123], v[88:91], v[240:255]
  s_waitcnt lgkmcnt(0)
  v_mfma_f32_32x32x16_bf16 v[240:255], v[124:127], v[92:95], v[240:255]
  s_nop 11
  v_fma_f32 v144, v144, v240, v176
  v_fma_f32 v145, v145, v241, v177
  v_fma_f32 v146, v146, v242, v178
  v_fma_f32 v147, v147, v243, v179
  v_fma_f32 v148, v148, v244, v180
  v_fma_f32 v149, v149, v245, v181
  v_fma_f32 v150, v150, v246, v182
  v_fma_f32 v151, v151, v247, v183
  v_fma_f32 v152, v152, v248, v184
  v_fma_f32 v153, v153, v249, v185
  v_fma_f32 v154, v154, v250, v186
  v_fma_f32 v155, v155, v251, v187
  v_fma_f32 v156, v156, v252, v188
  v_fma_f32 v157, v157, v253, v189
  v_fma_f32 v158, v158, v254, v190
  v_fma_f32 v159, v159, v255, v191
  v_cvt_pk_bf16_f32 v128, v144, v145
  v_cvt_pk_bf16_f32 v129, v146, v147
  v_cvt_pk_bf16_f32 v130, v148, v149
  v_cvt_pk_bf16_f32 v131, v150, v151
  v_cvt_pk_bf16_f32 v132, v152, v153
  v_cvt_pk_bf16_f32 v133, v154, v155
  v_cvt_pk_bf16_f32 v134, v156, v157
  v_cvt_pk_bf16_f32 v135, v158, v159
  buffer_store_dwordx2 v[128:129], v12, s[64:67], 0 offen offset:0
  buffer_store_dwordx2 v[130:131], v12, s[64:67], 0 offen offset:16
  buffer_store_dwordx2 v[132:133], v12, s[64:67], 0 offen offset:32
  buffer_store_dwordx2 v[134:135], v12, s[64:67], 0 offen offset:48
  s_waitcnt vmcnt(0) lgkmcnt(0)
  s_branch P_END
B_MAIN:
  s_waitcnt vmcnt(10)
  s_waitcnt lgkmcnt(0)
  s_barrier
  s_lshl_b32 s98, s85, 2
  s_add_u32 s98, s98, s18
  s_lshr_b32 s72, s84, 1
  s_lshl_b32 s72, s72, 7
  s_add_u32 s98, s98, s72
  s_and_b32 s99, s84, 1
  s_mul_i32 s72, s98, 1024
  s_mul_i32 s73, s99, 512
  s_add_u32 s72, s72, s73
  s_add_u32 s88, s44, s72
  s_addc_u32 s89, s45, 0
  s_mul_i32 s72, s98, 3072
  s_mul_i32 s73, s99, 512
  s_add_u32 s72, s72, s73
  s_add_u32 s86, s36, s72
  s_addc_u32 s87, s37, 0
  s_mul_i32 s72, s98, 3584
  s_mul_i32 s73, s99, 1536
  s_add_u32 s72, s72, s73
  s_add_u32 s90, s48, s72
  s_addc_u32 s91, s49, 0
  s_min_u32 s73, s98, 447
  s_mul_i32 s72, s73, 4096
  s_mul_i32 s73, s99, 512
  s_add_u32 s72, s72, s73
  s_add_u32 s92, s52, s72
  s_addc_u32 s93, s53, 0
  s_mul_i32 s72, s98, 1024
  s_mul_i32 s73, s99, 512
  s_add_u32 s72, s72, s73
  s_add_u32 s94, s56, s72
  s_addc_u32 s95, s57, 0
  s_load_dword s96, s[88:89], 0x0
  s_load_dword s96, s[88:89], 0x40
  s_load_dword s96, s[88:89], 0x80
  s_load_dword s96, s[88:89], 0xc0
  s_load_dword s96, s[88:89], 0x100
  s_load_dword s96, s[88:89], 0x140
  s_load_dword s96, s[88:89], 0x180
  s_load_dword s96, s[88:89], 0x1c0
  s_lshl_b32 s98, s85, 2
  s_add_u32 s98, s98, s18
  s_and_b32 s99, s84, 1
  v_mov_b32 v27, v0
  s_lshr_b32 s72, s98, 6
  v_lshl_add_u32 v28, v27, 1, s72
  v_mul_u32_u24 v29, 37, v28
  v_lshrrev_b32 v29, 8, v29
  v_mul_u32_u24 v30, 7, v29
  v_sub_u32 v28, v28, v30
  v_lshlrev_b32 v28, 8, v28
  v_lshl_add_u32 v28, v29, 6, v28
  s_and_b32 s72, s98, 63
  v_add_u32 v28, s72, v28
  v_lshlrev_b32 v28, 10, v28
  s_cmp_eq_u32 s99, 0
  s_mov_b32 s72, 0x7f000000
  s_cselect_b32 s73, 0, s72
  s_or_b32 s73, s73, 384
  v_or_b32 v70, s73, v28
  v_lshl_add_u32 v28, v27, 7, s98
  v_mul_u32_u24 v28, 1024, v28
  s_cmp_eq_u32 s99, 0
  s_mov_b32 s72, 0x7f000000
  s_cselect_b32 s73, 0, s72
  s_or_b32 s73, s73, 384
  s_and_b32 s72, s73, 0x7f000000
  v_add_u32 v28, 384, v28
  v_or_b32 v71, s72, v28
  v_lshl_add_u32 v28, v27, 7, s98
  v_mul_u32_u24 v28, 1024, v28
  s_cmp_eq_u32 s99, 0
  s_mov_b32 s72, 0x7f000000
  s_cselect_b32 s73, 0, s72
  s_or_b32 s73, s73, 384
  s_and_b32 s72, s73, 0x7f000000
  v_add_u32 v28, 384, v28
  v_or_b32 v73, s72, v28
  v_lshl_add_u32 v28, v27, 7, s98
  v_mul_u32_u24 v28, 3072, v28
  s_cmp_eq_u32 s99, 0
  s_mov_b32 s72, 0x7f000000
  s_cselect_b32 s73, 0, s72
  s_or_b32 s73, s73, 384
  s_and_b32 s72, s73, 0x7f000000
  v_add_u32 v28, 384, v28
  v_or_b32 v74, s72, v28
  s_barrier
  s_add_u32 m0, s4, 0
  s_add_u32 s72, s5, 0x400
  buffer_load_dwordx4 v4, s[36:39], s72 offen offset:0 lds
  buffer_load_dwordx4 v5, s[36:39], s72 offen offset:1024 lds
  buffer_load_dwordx4 v6, s[36:39], s72 offen offset:2048 lds
  buffer_load_dwordx4 v7, s[36:39], s72 offen offset:3072 lds
  s_add_u32 m0, s4, 4096
  s_add_u32 s72, s5, 0x18400
  buffer_load_dwordx4 v4, s[36:39], s72 offen offset:0 lds
  buffer_load_dwordx4 v5, s[36:39], s72 offen offset:1024 lds
  buffer_load_dwordx4 v6, s[36:39], s72 offen offset:2048 lds
  buffer_load_dwordx4 v7, s[36:39], s72 offen offset:3072 lds
  s_load_dword s96, s[86:87], 0x0
  s_load_dword s96, s[86:87], 0x40
  s_load_dword s96, s[86:87], 0x80
  s_load_dword s96, s[86:87], 0xc0
  s_load_dword s96, s[86:87], 0x100
  s_load_dword s96, s[86:87], 0x140
  s_load_dword s96, s[86:87], 0x180
  s_load_dword s96, s[86:87], 0x1c0
  s_mov_b32 exec_lo, 0x1
  s_mov_b32 exec_hi, 0x0
  buffer_load_dword v72, v73, s[44:47], 0 offen
  s_mov_b64 exec, -1
  s_waitcnt vmcnt(10)
  s_barrier
  s_add_u32 m0, s4, 32768
  s_add_u32 s72, s5, 0xc0400
  buffer_load_dwordx4 v4, s[36:39], s72 offen offset:0 lds
  buffer_load_dwordx4 v5, s[36:39], s72 offen offset:1024 lds
  buffer_load_dwordx4 v6, s[36:39], s72 offen offset:2048 lds
  buffer_load_dwordx4 v7, s[36:39], s72 offen offset:3072 lds
  s_add_u32 m0, s4, 36864
  s_add_u32 s72, s5, 0xd8400
  buffer_load_dwordx4 v4, s[36:39], s72 offen offset:0 lds
  buffer_load_dwordx4 v5, s[36:39], s72 offen offset:1024 lds
  buffer_load_dwordx4 v6, s[36:39], s72 offen offset:2048 lds
  buffer_load_dwordx4 v7, s[36:39], s72 offen offset:3072 lds
  s_waitcnt vmcnt(17)
  v_readfirstlane_b32 s29, v63
  s_cmp_lg_u32 s29, 0
  s_cbranch_scc1 ND_7
NC_6:
  v_mov_b32 v59, 0
  buffer_load_dword v63, v59, s[68:71], 0 offen sc1
  s_waitcnt vmcnt(0)
  v_readfirstlane_b32 s29, v63
  s_sub_u32 s78, s78, 1
  s_cmp_le_i32 s78, 0
  s_cbranch_scc1 ND_7
  s_cmp_eq_u32 s29, 0
  s_cbranch_scc1 NC_6
ND_7:
  v_mov_b32 v19, s29
  s_load_dword s96, s[90:91], 0x0
  s_load_dword s96, s[90:91], 0x40
  s_load_dword s96, s[90:91], 0x80
  s_load_dword s96, s[90:91], 0xc0
  s_load_dword s96, s[90:91], 0x100
  s_load_dword s96, s[90:91], 0x140
  s_load_dword s96, s[90:91], 0x180
  s_load_dword s96, s[90:91], 0x1c0
  s_mov_b32 exec_lo, 0x2
  s_mov_b32 exec_hi, 0x0
  buffer_load_dword v72, v73, s[44:47], 0 offen
  s_mov_b64 exec, -1
  s_waitcnt vmcnt(10)
  s_barrier
  s_add_u32 m0, s4, 65536
  s_add_u32 s72, s5, 0x800
  buffer_load_dwordx4 v4, s[36:39], s72 offen offset:0 lds
  buffer_load_dwordx4 v5, s[36:39], s72 offen offset:1024 lds
  buffer_load_dwordx4 v6, s[36:39], s72 offen offset:2048 lds
  buffer_load_dwordx4 v7, s[36:39], s72 offen offset:3072 lds
  s_add_u32 m0, s4, 69632
  s_add_u32 s72, s5, 0x18800
  buffer_load_dwordx4 v4, s[36:39], s72 offen offset:0 lds
  buffer_load_dwordx4 v5, s[36:39], s72 offen offset:1024 lds
  buffer_load_dwordx4 v6, s[36:39], s72 offen offset:2048 lds
  buffer_load_dwordx4 v7, s[36:39], s72 offen offset:3072 lds
  s_load_dword s96, s[90:91], 0x200
  s_load_dword s96, s[90:91], 0x240
  s_load_dword s96, s[90:91], 0x280
  s_load_dword s96, s[90:91], 0x2c0
  s_load_dword s96, s[90:91], 0x300
  s_load_dword s96, s[90:91], 0x340
  s_load_dword s96, s[90:91], 0x380
  s_load_dword s96, s[90:91], 0x3c0
  s_mov_b32 exec_lo, 0x4
  s_mov_b32 exec_hi, 0x0
  buffer_load_dword v72, v73, s[44:47], 0 offen
  s_mov_b64 exec, -1
  s_waitcnt vmcnt(10)
  s_barrier
  s_add_u32 m0, s4, 98304
  s_add_u32 s72, s5, 0xc0800
  buffer_load_dwordx4 v4, s[36:39], s72 offen offset:0 lds
  buffer_load_dwordx4 v5, s[36:39], s72 offen offset:1024 lds
  buffer_load_dwordx4 v6, s[36:39], s72 offen offset:2048 lds
  buffer_load_dwordx4 v7, s[36:39], s72 offen offset:3072 lds
  s_add_u32 m0, s4, 102400
  s_add_u32 s72, s5, 0xd8800
  buffer_load_dwordx4 v4, s[36:39], s72 offen offset:0 lds
  buffer_load_dwordx4 v5, s[36:39], s72 offen offset:1024 lds
  buffer_load_dwordx4 v6, s[36:39], s72 offen offset:2048 lds
  buffer_load_dwordx4 v7, s[36:39], s72 offen offset:3072 lds
  s_load_dword s96, s[90:91], 0x400
  s_load_dword s96, s[90:91], 0x440
  s_load_dword s96, s[90:91], 0x480
  s_load_dword s96, s[90:91], 0x4c0
  s_load_dword s96, s[90:91], 0x500
  s_load_dword s96, s[90:91], 0x540
  s_load_dword s96, s[90:91], 0x580
  s_load_dword s96, s[90:91], 0x5c0
  s_mov_b32 exec_lo, 0x8
  s_mov_b32 exec_hi, 0x0
  buffer_load_dword v72, v73, s[44:47], 0 offen
  s_mov_b64 exec, -1
  s_waitcnt vmcnt(10)
  s_barrier
  s_add_u32 m0, s8, 0
  s_add_u32 s72, s9, 0x0
  buffer_load_dwordx4 v8, s[44:47], s72 offen offset:0 lds
  buffer_load_dwordx4 v9, s[44:47], s72 offen offset:1024 lds
  buffer_load_dwordx4 v10, s[44:47], s72 offen offset:2048 lds
  buffer_load_dwordx4 v11, s[44:47], s72 offen offset:3072 lds
  v_lshrrev_b32 v157, 3, v0
  v_and_b32 v158, 7, v0
  v_mul_u32_u24 v156, 3584, v157
  v_lshl_add_u32 v156, v158, 4, v156
  s_mul_i32 s73, s20, 114688
  s_lshl_b32 s74, s22, 7
  s_add_u32 s73, s73, s74
  s_cmp_eq_u32 s21, 0
  s_cselect_b32 s73, s73, 0
  v_or_b32 v156, s21, v156
  buffer_load_dwordx4 v[128:131], v156, s[48:51], s73 offen
  s_add_u32 s73, s73, 28672
  buffer_load_dwordx4 v[132:135], v156, s[48:51], s73 offen
  s_add_u32 s73, s73, 28672
  buffer_load_dwordx4 v[136:139], v156, s[48:51], s73 offen
  s_add_u32 s73, s73, 28672
  buffer_load_dwordx4 v[140:143], v156, s[48:51], s73 offen
  s_load_dword s96, s[90:91], 0x600
  s_load_dword s96, s[90:91], 0x640
  s_load_dword s96, s[90:91], 0x680
  s_load_dword s96, s[90:91], 0x6c0
  s_load_dword s96, s[90:91], 0x700
  s_load_dword s96, s[90:91], 0x740
  s_load_dword s96, s[90:91], 0x780
  s_load_dword s96, s[90:91], 0x7c0
  s_mov_b32 exec_lo, 0x1
  s_mov_b32 exec_hi, 0x0
  buffer_load_dword v72, v74, s[36:39], 0 offen
  s_mov_b64 exec, -1
  s_waitcnt vmcnt(10)
  s_barrier
  v_lshrrev_b32 v22, 3, v0
  s_lshl_b32 s72, s18, 4
  v_add_u32 v24, s72, v22
  v_bfe_u32 v25, v24, 1, 3
  v_and_b32 v26, 7, v0
  v_xor_b32 v25, v25, v26
  v_lshlrev_b32 v25, 4, v25
  s_lshl_b32 s72, s27, 6
  v_add_u32 v24, s72, v24
  v_lshl_add_u32 v24, v24, 10, v25
  s_lshl_b32 s72, s28, 7
  v_add_u32 v24, s72, v24
  s_lshl_b32 s72, s18, 11
  s_add_u32 m0, s72, 147456
  s_nop 0
  buffer_load_dwordx4 v24, s[32:35], 0 offen lds
  v_add_u32 v24, 8192 - 1024, v24
  v_xor_b32 v24, 64, v24
  buffer_load_dwordx4 v24, s[32:35], 0 offen offset:1024 lds
  s_add_u32 m0, s8, 32768
  s_add_u32 s72, s9, 0x20000
  buffer_load_dwordx4 v8, s[44:47], s72 offen offset:0 lds
  buffer_load_dwordx4 v9, s[44:47], s72 offen offset:1024 lds
  buffer_load_dwordx4 v10, s[44:47], s72 offen offset:2048 lds
  buffer_load_dwordx4 v11, s[44:47], s72 offen offset:3072 lds
  s_load_dword s96, s[92:93], 0x0
  s_load_dword s96, s[92:93], 0x40
  s_load_dword s96, s[92:93], 0x80
  s_load_dword s96, s[92:93], 0xc0
  s_load_dword s96, s[92:93], 0x100
  s_load_dword s96, s[92:93], 0x140
  s_load_dword s96, s[92:93], 0x180
  s_load_dword s96, s[92:93], 0x1c0
  s_cmp_eq_u32 s27, 0
  s_cselect_b32 s80, 0xffff0000, -1
  s_cmp_eq_u32 s27, 31
  s_cselect_b32 s81, 0, 0xffff
  s_lshl_b32 s72, s19, 5
  s_add_u32 s72, s72, 0xffffffff
  v_add_u32 v36, s72, v1
  v_ashrrev_i32 v29, 5, v36
  v_lshlrev_b32 v29, 15, v29
  v_and_b32 v30, 31, v36
  v_lshl_add_u32 v29, v30, 4, v29
  v_lshl_add_u32 v29, v2, 9, v29
  v_cmp_gt_u32 vcc, 0x800, v36
  v_mov_b32 v30, 0x7f000000
  s_nop 0
  v_cndmask_b32 v32, v30, v29, vcc
  s_lshl_b32 s72, s19, 5
  s_add_u32 s72, s72, 0x1
  v_add_u32 v36, s72, v1
  v_ashrrev_i32 v29, 5, v36
  v_lshlrev_b32 v29, 15, v29
  v_and_b32 v30, 31, v36
  v_lshl_add_u32 v29, v30, 4, v29
  v_lshl_add_u32 v29, v2, 9, v29
  v_cmp_gt_u32 vcc, 0x800, v36
  v_mov_b32 v30, 0x7f000000
  s_nop 0
  v_cndmask_b32 v33, v30, v29, vcc
  s_lshl_b32 s72, s19, 5
  s_add_u32 s72, s72, 0xfffffffe
  v_add_u32 v36, s72, v1
  v_ashrrev_i32 v29, 5, v36
  v_lshlrev_b32 v29, 15, v29
  v_and_b32 v30, 31, v36
  v_lshl_add_u32 v29, v30, 4, v29
  v_lshl_add_u32 v29, v2, 9, v29
  v_cmp_gt_u32 vcc, 0x800, v36
  v_mov_b32 v30, 0x7f000000
  s_nop 0
  v_cndmask_b32 v34, v30, v29, vcc
  s_lshl_b32 s72, s19, 5
  s_add_u32 s72, s72, 0x2
  v_add_u32 v36, s72, v1
  v_ashrrev_i32 v29, 5, v36
  v_lshlrev_b32 v29, 15, v29
  v_and_b32 v30, 31, v36
  v_lshl_add_u32 v29, v30, 4, v29
  v_lshl_add_u32 v29, v2, 9, v29
  v_cmp_gt_u32 vcc, 0x800, v36
  v_mov_b32 v30, 0x7f000000
  s_nop 0
  v_cndmask_b32 v35, v30, v29, vcc
  s_add_u32 m0, s8, 65536
  s_add_u32 s72, s9, 0x40000
  buffer_load_dwordx4 v8, s[44:47], s72 offen offset:0 lds
  buffer_load_dwordx4 v9, s[44:47], s72 offen offset:1024 lds
  buffer_load_dwordx4 v10, s[44:47], s72 offen offset:2048 lds
  buffer_load_dwordx4 v11, s[44:47], s72 offen offset:3072 lds
  s_mov_b32 exec_lo, 0x2
  s_mov_b32 exec_hi, 0x0
  buffer_load_dword v72, v74, s[36:39], 0 offen
  s_mov_b64 exec, -1
  v_lshlrev_b32 v28, 3, v0
  s_lshl_b32 s73, s27, 7
  s_add_u32 s73, s73, 0x1700000
  buffer_load_dwordx2 v[30:31], v28, s[60:63], s73 offen sc1
  s_mov_b32 s101, s73
  s_waitcnt vmcnt(13)
  v_lshlrev_b32 v144, 16, v128
  v_and_b32 v145, 0xffff0000, v128
  v_lshlrev_b32 v146, 16, v129
  v_and_b32 v147, 0xffff0000, v129
  v_lshlrev_b32 v148, 16, v130
  v_and_b32 v149, 0xffff0000, v130
  v_lshlrev_b32 v150, 16, v131
  v_and_b32 v151, 0xffff0000, v131
  v_lshlrev_b32 v152, 16, v132
  v_and_b32 v153, 0xffff0000, v132
  v_pk_add_f32 v[144:145], v[144:145], v[152:153]
  v_lshlrev_b32 v154, 16, v133
  v_and_b32 v155, 0xffff0000, v133
  v_pk_add_f32 v[146:147], v[146:147], v[154:155]
  v_lshlrev_b32 v152, 16, v134
  v_and_b32 v153, 0xffff0000, v134
  v_pk_add_f32 v[148:149], v[148:149], v[152:153]
  v_lshlrev_b32 v154, 16, v135
  v_and_b32 v155, 0xffff0000, v135
  v_pk_add_f32 v[150:151], v[150:151], v[154:155]
  v_lshlrev_b32 v152, 16, v136
  v_and_b32 v153, 0xffff0000, v136
  v_pk_add_f32 v[144:145], v[144:145], v[152:153]
  v_lshlrev_b32 v154, 16, v137
  v_and_b32 v155, 0xffff0000, v137
  v_pk_add_f32 v[146:147], v[146:147], v[154:155]
  v_lshlrev_b32 v152, 16, v138
  v_and_b32 v153, 0xffff0000, v138
  v_pk_add_f32 v[148:149], v[148:149], v[152:153]
  v_lshlrev_b32 v154, 16, v139
  v_and_b32 v155, 0xffff0000, v139
  v_pk_add_f32 v[150:151], v[150:151], v[154:155]
  v_lshlrev_b32 v152, 16, v140
  v_and_b32 v153, 0xffff0000, v140
  v_pk_add_f32 v[144:145], v[144:145], v[152:153]
  v_lshlrev_b32 v154, 16, v141
  v_and_b32 v155, 0xffff0000, v141
  v_pk_add_f32 v[146:147], v[146:147], v[154:155]
  v_lshlrev_b32 v152, 16, v142
  v_and_b32 v153, 0xffff0000, v142
  v_pk_add_f32 v[148:149], v[148:149], v[152:153]
  v_lshlrev_b32 v154, 16, v143
  v_and_b32 v155, 0xffff0000, v143
  v_pk_add_f32 v[150:151], v[150:151], v[154:155]
  v_permlane32_swap_b32 v144, v148
  v_permlane32_swap_b32 v145, v149
  v_permlane32_swap_b32 v146, v150
  v_permlane32_swap_b32 v147, v151
  v_add_f32 v144, v144, v148
  v_add_f32 v145, v145, v149
  v_add_f32 v146, v146, v150
  v_add_f32 v147, v147, v151
  s_nop 0
  v_permlane16_swap_b32 v144, v146
  v_permlane16_swap_b32 v145, v147
  v_add_f32 v144, v144, v146
  v_add_f32 v145, v145, v147
  s_nop 0
  v_add_f32_dpp v144, v144, v144 row_ror:8 row_mask:0xf bank_mask:0xf
  v_add_f32_dpp v145, v145, v145 row_ror:8 row_mask:0xf bank_mask:0xf
  v_and_b32 v158, 8, v0
  v_cmp_eq_u32 vcc, 0, v158
  s_nop 1
  v_cndmask_b32 v144, v145, v144, vcc
  v_and_b32 v158, 7, v0
  v_lshrrev_b32 v157, 3, v0
  v_lshlrev_b32 v157, 2, v157
  v_lshl_add_u32 v157, v158, 5, v157
  s_lshl_b32 s72, s18, 8
  s_add_u32 s72, s72, 158720
  v_add_u32 v157, s72, v157
  ds_write_b32 v157, v144
  s_waitcnt vmcnt(0)
  v_cmp_ne_u32 vcc, s29, v30
  v_cmp_ne_u32 s[76:77], s29, v31
  s_or_b64 vcc, vcc, s[76:77]
  s_and_b64 vcc, vcc, s[80:81]
  s_cbranch_scc0 F1OK_8
PL_9:
  buffer_load_dwordx2 v[30:31], v28, s[60:63], s101 offen sc1
  s_waitcnt vmcnt(0)
  v_cmp_ne_u32 vcc, s29, v30
  v_cmp_ne_u32 s[76:77], s29, v31
  s_or_b64 vcc, vcc, s[76:77]
  s_and_b64 vcc, vcc, s[80:81]
  s_cbranch_scc0 PD_10
  s_sub_u32 s78, s78, 1
  s_cmp_gt_i32 s78, 0
  s_cbranch_scc1 PL_9
PD_10:
F1OK_8:
  s_add_u32 m0, s8, 8192
  s_add_u32 s72, s24, 0x0
  buffer_load_dwordx4 v32, s[60:63], s72 offen offset:0 sc1 lds
  buffer_load_dwordx4 v32, s[60:63], s72 offen offset:1024 sc1 lds
  buffer_load_dwordx4 v32, s[60:63], s72 offen offset:2048 sc1 lds
  buffer_load_dwordx4 v32, s[60:63], s72 offen offset:3072 sc1 lds
  s_add_u32 m0, s8, 40960
  s_add_u32 s72, s24, 0x2000
  buffer_load_dwordx4 v33, s[60:63], s72 offen offset:0 sc1 lds
  buffer_load_dwordx4 v33, s[60:63], s72 offen offset:1024 sc1 lds
  buffer_load_dwordx4 v33, s[60:63], s72 offen offset:2048 sc1 lds
  buffer_load_dwordx4 v33, s[60:63], s72 offen offset:3072 sc1 lds
  s_waitcnt lgkmcnt(0)
  s_barrier
  s_add_u32 m0, s8, 73728
  s_add_u32 s72, s24, 0x4000
  buffer_load_dwordx4 v34, s[60:63], s72 offen offset:0 sc1 lds
  buffer_load_dwordx4 v34, s[60:63], s72 offen offset:1024 sc1 lds
  buffer_load_dwordx4 v34, s[60:63], s72 offen offset:2048 sc1 lds
  buffer_load_dwordx4 v34, s[60:63], s72 offen offset:3072 sc1 lds
  v_add_u32 v157, 158720, v21
  ds_read_b32 v144, v157 offset:0
  ds_read_b32 v145, v157 offset:256
  ds_read_b32 v146, v157 offset:512
  ds_read_b32 v147, v157 offset:768
  s_cmp_eq_u32 s18, 0
  s_cselect_b32 s72, s21, 0x7f000000
  v_or_b32 v157, s72, v21
  v_or_b32 v159, s72, v20
  s_lshr_b32 s73, s27, 2
  s_lshl_b32 s72, s22, 10
  s_lshl_b32 s74, s73, 8
  s_add_u32 s72, s72, s74
  s_add_u32 s101, s72, 0x1600000
  s_lshl_b32 s72, s28, 6
  s_add_u32 s72, s72, s73
  s_and_b32 s73, s27, 3
  s_lshl_b32 s73, s73, 2
  s_add_u32 s72, s72, s73
  s_lshl_b32 s72, s72, 2
  s_add_u32 s25, s72, 0x170a000
  s_waitcnt lgkmcnt(0)
  v_add_f32 v144, v144, v145
  v_add_f32 v146, v146, v147
  v_add_f32 v144, v144, v146
  buffer_store_dword v144, v157, s[60:63], s101 offen sc1
  s_mov_b32 exec_lo, 0x4
  s_mov_b32 exec_hi, 0x0
  buffer_load_dword v72, v74, s[36:39], 0 offen
  s_mov_b64 exec, -1
  s_waitcnt vmcnt(10)
  s_barrier
  s_add_u32 m0, s8, 98304
  s_add_u32 s72, s9, 0x60000
  buffer_load_dwordx4 v8, s[44:47], s72 offen offset:0 lds
  buffer_load_dwordx4 v9, s[44:47], s72 offen offset:1024 lds
  buffer_load_dwordx4 v10, s[44:47], s72 offen offset:2048 lds
  buffer_load_dwordx4 v11, s[44:47], s72 offen offset:3072 lds
  s_mov_b32 exec_lo, 0x8
  s_mov_b32 exec_hi, 0x0
  buffer_load_dword v72, v74, s[36:39], 0 offen
  s_mov_b64 exec, -1
  s_waitcnt vmcnt(11)
  s_barrier
  s_add_u32 m0, s8, 106496
  s_add_u32 s72, s24, 0x6000
  buffer_load_dwordx4 v35, s[60:63], s72 offen offset:0 sc1 lds
  buffer_load_dwordx4 v35, s[60:63], s72 offen offset:1024 sc1 lds
  buffer_load_dwordx4 v35, s[60:63], s72 offen offset:2048 sc1 lds
  buffer_load_dwordx4 v35, s[60:63], s72 offen offset:3072 sc1 lds
  s_load_dword s96, s[92:93], 0x400
  s_load_dword s96, s[92:93], 0x440
  s_load_dword s96, s[92:93], 0x480
  s_load_dword s96, s[92:93], 0x4c0
  s_load_dword s96, s[92:93], 0x500
  s_load_dword s96, s[92:93], 0x540
  s_load_dword s96, s[92:93], 0x580
  s_load_dword s96, s[92:93], 0x5c0
  s_waitcnt vmcnt(11)
  s_barrier
  s_sub_u32 s5, s5, s3
  s_lshl_b32 s100, s28, 8
  s_add_u32 s100, s100, 0x170a000
  s_add_u32 m0, s4, 0
  s_add_u32 s72, s5, 0x0
  buffer_load_dwordx4 v4, s[36:39], s72 offen offset:0 lds
  buffer_load_dwordx4 v5, s[36:39], s72 offen offset:1024 lds
  buffer_load_dwordx4 v6, s[36:39], s72 offen offset:2048 lds
  buffer_load_dwordx4 v7, s[36:39], s72 offen offset:3072 lds
  s_add_u32 m0, s4, 4096
  s_add_u32 s72, s5, 0x18000
  buffer_load_dwordx4 v4, s[36:39], s72 offen offset:0 lds
  buffer_load_dwordx4 v5, s[36:39], s72 offen offset:1024 lds
  buffer_load_dwordx4 v6, s[36:39], s72 offen offset:2048 lds
  buffer_load_dwordx4 v7, s[36:39], s72 offen offset:3072 lds
  s_load_dword s96, s[92:93], 0x800
  s_load_dword s96, s[92:93], 0x840
  s_load_dword s96, s[92:93], 0x880
  s_load_dword s96, s[92:93], 0x8c0
  s_load_dword s96, s[92:93], 0x900
  s_load_dword s96, s[92:93], 0x940
  s_load_dword s96, s[92:93], 0x980
  s_load_dword s96, s[92:93], 0x9c0
  s_waitcnt vmcnt(8)
  s_barrier
  buffer_store_dword v19, v159, s[60:63], s25 offen sc1
  s_add_u32 m0, s4, 32768
  s_add_u32 s72, s5, 0xc0000
  buffer_load_dwordx4 v4, s[36:39], s72 offen offset:0 lds
  buffer_load_dwordx4 v5, s[36:39], s72 offen offset:1024 lds
  buffer_load_dwordx4 v6, s[36:39], s72 offen offset:2048 lds
  buffer_load_dwordx4 v7, s[36:39], s72 offen offset:3072 lds
  s_add_u32 m0, s4, 36864
  s_add_u32 s72, s5, 0xd8000
  buffer_load_dwordx4 v4, s[36:39], s72 offen offset:0 lds
  buffer_load_dwordx4 v5, s[36:39], s72 offen offset:1024 lds
  buffer_load_dwordx4 v6, s[36:39], s72 offen offset:2048 lds
  buffer_load_dwordx4 v7, s[36:39], s72 offen offset:3072 lds
  s_load_dword s96, s[92:93], 0xc00
  s_load_dword s96, s[92:93], 0xc40
  s_load_dword s96, s[92:93], 0xc80
  s_load_dword s96, s[92:93], 0xcc0
  s_load_dword s96, s[92:93], 0xd00
  s_load_dword s96, s[92:93], 0xd40
  s_load_dword s96, s[92:93], 0xd80
  s_load_dword s96, s[92:93], 0xdc0
  s_waitcnt vmcnt(9)
  s_barrier
  s_waitcnt vmcnt(0)
  s_barrier
  s_add_u32 m0, s4, 0
  s_add_u32 s72, s7, 0x0
  buffer_load_dwordx4 v12, s[48:51], s72 offen offset:0 lds
  buffer_load_dwordx4 v13, s[48:51], s72 offen offset:1024 lds
  buffer_load_dwordx4 v14, s[48:51], s72 offen offset:2048 lds
  buffer_load_dwordx4 v15, s[48:51], s72 offen offset:3072 lds
  s_add_u32 m0, s4, 4096
  s_add_u32 s72, s7, 0x1c000
  buffer_load_dwordx4 v12, s[48:51], s72 offen offset:0 lds
  buffer_load_dwordx4 v13, s[48:51], s72 offen offset:1024 lds
  buffer_load_dwordx4 v14, s[48:51], s72 offen offset:2048 lds
  buffer_load_dwordx4 v15, s[48:51], s72 offen offset:3072 lds
  s_load_dword s96, s[94:95], 0x0
  s_load_dword s96, s[94:95], 0x40
  s_load_dword s96, s[94:95], 0x80
  s_load_dword s96, s[94:95], 0xc0
  s_load_dword s96, s[94:95], 0x100
  s_load_dword s96, s[94:95], 0x140
  s_load_dword s96, s[94:95], 0x180
  s_load_dword s96, s[94:95], 0x1c0
  buffer_load_dword v45, v21, s[60:63], s100 offen sc1
  s_barrier
  s_add_u32 m0, s4, 32768
  s_add_u32 s72, s7, 0xe0000
  buffer_load_dwordx4 v12, s[48:51], s72 offen offset:0 lds
  buffer_load_dwordx4 v13, s[48:51], s72 offen offset:1024 lds
  buffer_load_dwordx4 v14, s[48:51], s72 offen offset:2048 lds
  buffer_load_dwordx4 v15, s[48:51], s72 offen offset:3072 lds
  s_add_u32 m0, s4, 36864
  s_add_u32 s72, s7, 0xfc000
  buffer_load_dwordx4 v12, s[48:51], s72 offen offset:0 lds
  buffer_load_dwordx4 v13, s[48:51], s72 offen offset:1024 lds
  buffer_load_dwordx4 v14, s[48:51], s72 offen offset:2048 lds
  buffer_load_dwordx4 v15, s[48:51], s72 offen offset:3072 lds
  s_lshl_b32 s73, s27, 7
  s_add_u32 s73, s73, 0x1702000
  s_mov_b32 s80, 0xffffffff
  s_mov_b32 s81, 0x0
PL_11:
  buffer_load_dword v30, v21, s[60:63], s73 offen sc1
  s_waitcnt vmcnt(0)
  v_cmp_ne_u32 vcc, s29, v30
  s_and_b64 vcc, vcc, s[80:81]
  s_cbranch_scc0 PD_12
  s_sub_u32 s78, s78, 1
  s_cmp_gt_i32 s78, 0
  s_cbranch_scc1 PL_11
PD_12:
  s_lshl_b32 s72, s30, 14
  s_lshl_b32 s73, s31, 13
  s_add_u32 s74, s72, s73
  s_add_u32 m0, s74, 65536
  s_add_u32 s72, s15, 0x0
  buffer_load_dwordx4 v16, s[60:63], s72 offen offset:0 sc1 lds
  buffer_load_dwordx4 v16, s[60:63], s72 offen offset:1024 sc1 lds
  buffer_load_dwordx4 v16, s[60:63], s72 offen offset:2048 sc1 lds
  buffer_load_dwordx4 v16, s[60:63], s72 offen offset:3072 sc1 lds
  s_add_u32 m0, s74, 69632
  s_add_u32 s72, s15, 0x1000
  buffer_load_dwordx4 v16, s[60:63], s72 offen offset:0 sc1 lds
  buffer_load_dwordx4 v16, s[60:63], s72 offen offset:1024 sc1 lds
  buffer_load_dwordx4 v16, s[60:63], s72 offen offset:2048 sc1 lds
  buffer_load_dwordx4 v16, s[60:63], s72 offen offset:3072 sc1 lds
  s_cmp_eq_u32 s28, 7
  s_cselect_b32 s80, 0, 0xffff
  s_mov_b32 s81, 0
  v_cmp_ne_u32 vcc, s29, v45
  s_and_b64 vcc, vcc, s[80:81]
  s_cbranch_scc0 AOK_13
PL_14:
  buffer_load_dword v45, v21, s[60:63], s100 offen sc1
  s_waitcnt vmcnt(0)
  v_cmp_ne_u32 vcc, s29, v45
  s_and_b64 vcc, vcc, s[80:81]
  s_cbranch_scc0 PD_15
  s_sub_u32 s78, s78, 1
  s_cmp_gt_i32 s78, 0
  s_cbranch_scc1 PL_14
PD_15:
AOK_13:
  s_lshl_b32 s72, s28, 2
  s_add_u32 s72, s72, s18
  s_lshl_b32 s72, s72, 10
  s_add_u32 s72, s72, 0x1600000
  buffer_load_dword v112, v21, s[60:63], s72 offen offset:0 sc1
  buffer_load_dword v113, v21, s[60:63], s72 offen offset:256 sc1
  buffer_load_dword v114, v21, s[60:63], s72 offen offset:512 sc1
  buffer_load_dword v115, v21, s[60:63], s72 offen offset:768 sc1
  s_lshl_b32 s72, s30, 14
  s_lshl_b32 s73, s31, 13
  s_add_u32 s74, s72, s73
  s_add_u32 m0, s74, 98304
  s_add_u32 s72, s15, 0x4000
  buffer_load_dwordx4 v16, s[60:63], s72 offen offset:0 sc1 lds
  buffer_load_dwordx4 v16, s[60:63], s72 offen offset:1024 sc1 lds
  buffer_load_dwordx4 v16, s[60:63], s72 offen offset:2048 sc1 lds
  buffer_load_dwordx4 v16, s[60:63], s72 offen offset:3072 sc1 lds
  s_add_u32 m0, s74, 102400
  s_add_u32 s72, s15, 0x5000
  buffer_load_dwordx4 v16, s[60:63], s72 offen offset:0 sc1 lds
  buffer_load_dwordx4 v16, s[60:63], s72 offen offset:1024 sc1 lds
  buffer_load_dwordx4 v16, s[60:63], s72 offen offset:2048 sc1 lds
  buffer_load_dwordx4 v16, s[60:63], s72 offen offset:3072 sc1 lds
  s_lshl_b32 s72, s27, 13
  s_lshl_b32 s73, s30, 8
  s_add_u32 s72, s72, s73
  s_add_u32 s72, s72, 0x1500000
  s_add_u32 s73, s72, 4096
  s_cmp_eq_u32 s31, 0
  s_cselect_b32 s74, 0, 0x7f000000
  v_or_b32 v46, s74, v21
  buffer_load_dword v96, v46, s[60:63], s72 offen offset:0 sc1
  buffer_load_dword v97, v46, s[60:63], s72 offen offset:512 sc1
  buffer_load_dword v98, v46, s[60:63], s72 offen offset:1024 sc1
  buffer_load_dword v99, v46, s[60:63], s72 offen offset:1536 sc1
  buffer_load_dword v100, v46, s[60:63], s72 offen offset:2048 sc1
  buffer_load_dword v101, v46, s[60:63], s72 offen offset:2560 sc1
  buffer_load_dword v102, v46, s[60:63], s72 offen offset:3072 sc1
  buffer_load_dword v103, v46, s[60:63], s72 offen offset:3584 sc1
  buffer_load_dword v104, v46, s[60:63], s73 offen offset:0 sc1
  buffer_load_dword v105, v46, s[60:63], s73 offen offset:512 sc1
  buffer_load_dword v106, v46, s[60:63], s73 offen offset:1024 sc1
  buffer_load_dword v107, v46, s[60:63], s73 offen offset:1536 sc1
  buffer_load_dword v108, v46, s[60:63], s73 offen offset:2048 sc1
  buffer_load_dword v109, v46, s[60:63], s73 offen offset:2560 sc1
  buffer_load_dword v110, v46, s[60:63], s73 offen offset:3072 sc1
  buffer_load_dword v111, v46, s[60:63], s73 offen offset:3584 sc1
  s_waitcnt vmcnt(28)
  s_barrier
  s_waitcnt vmcnt(0)
  v_add_f32 v96, v96, v104
  v_add_f32 v97, v97, v105
  v_add_f32 v98, v98, v106
  v_add_f32 v99, v99, v107
  v_add_f32 v100, v100, v108
  v_add_f32 v101, v101, v109
  v_add_f32 v102, v102, v110
  v_add_f32 v103, v103, v111
  v_add_f32 v96, v96, v100
  v_add_f32 v97, v97, v101
  v_add_f32 v98, v98, v102
  v_add_f32 v99, v99, v103
  v_add_f32 v96, v96, v98
  v_add_f32 v97, v97, v99
  v_add_f32 v96, v96, v97
  v_mov_b32 v97, v96
  s_nop 1
  v_permlane32_swap_b32 v96, v97
  v_mul_f32 v24, 0x3b000000, v96
  v_mul_f32 v97, 0x3b000000, v97
  v_fma_f32 v97, -v24, v24, v97
  v_max_f32 v97, 0, v97
  v_add_f32 v97, 0x3727c5ac, v97
  v_rsq_f32 v98, v97
  v_sqrt_f32 v27, v97
  v_mul_f32 v25, 0xc0135761, v98
  v_mul_f32 v26, v98, v98
  v_mul_f32 v26, v26, v98
  v_mul_f32 v26, 0xbdd2d3e8, v26
  s_lshl_b32 s72, s30, 9
  s_add_u32 s72, s72, 157696
  v_lshl_add_u32 v28, v1, 4, s72
  s_cmp_eq_u32 s31, 0
  s_cselect_b64 exec, -1, 0
  ds_write_b128 v28, v[24:27]
  s_mov_b64 exec, -1
  v_add_f32 v112, v112, v114
  v_add_f32 v113, v113, v115
  v_add_f32 v112, v112, v113
  s_lshl_b32 s72, s18, 8
  s_add_u32 s72, s72, 156672
  v_add_u32 v28, s72, v21
  ds_write_b32 v28, v112
  s_barrier
  s_add_u32 m0, s4, 65536
  s_add_u32 s72, s7, 0x80
  buffer_load_dwordx4 v12, s[48:51], s72 offen offset:0 lds
  buffer_load_dwordx4 v13, s[48:51], s72 offen offset:1024 lds
  buffer_load_dwordx4 v14, s[48:51], s72 offen offset:2048 lds
  buffer_load_dwordx4 v15, s[48:51], s72 offen offset:3072 lds
  s_add_u32 m0, s4, 69632
  s_add_u32 s72, s7, 0x1c080
  buffer_load_dwordx4 v12, s[48:51], s72 offen offset:0 lds
  buffer_load_dwordx4 v13, s[48:51], s72 offen offset:1024 lds
  buffer_load_dwordx4 v14, s[48:51], s72 offen offset:2048 lds
  buffer_load_dwordx4 v15, s[48:51], s72 offen offset:3072 lds
  s_mov_b32 exec_lo, 0x3
  s_mov_b32 exec_hi, 0x0
  buffer_load_dword v72, v70, s[52:55], 0 offen
  s_mov_b64 exec, -1
  s_barrier
  s_mov_b32 exec_lo, 0xc
  s_mov_b32 exec_hi, 0x0
  buffer_load_dword v72, v70, s[52:55], 0 offen
  s_mov_b64 exec, -1
  s_barrier
  s_cmp_eq_u32 s18, 0
  s_cselect_b32 s87, 0, 0x7f000000
  s_cselect_b32 s88, -1, 0
  s_lshl_b32 s89, s27, 7
  s_add_u32 s89, s89, 0x1708000
  buffer_load_dword v39, v21, s[60:63], s89 offen sc1
  v_lshrrev_b32 v28, 4, v0
  v_lshlrev_b32 v28, 11, v28
  v_bfe_u32 v29, v0, 3, 1
  v_lshl_add_u32 v28, v29, 10, v28
  v_and_b32 v30, 7, v0
  v_lshl_add_u32 v28, v30, 4, v28
  s_lshl_b32 s72, s28, 7
  v_add_u32 v28, s72, v28
  v_or_b32 v37, s87, v28
  v_lshlrev_b32 v30, 4, v30
  v_lshl_add_u32 v30, v29, 3, v30
  v_add_u32 v30, s72, v30
  v_mov_b32 v29, 0x7f000000
  v_cmp_gt_u32 vcc, 16, v0
  s_nop 1
  v_cndmask_b32 v30, v29, v30, vcc
  v_or_b32 v38, s87, v30
  s_barrier
  s_add_u32 m0, s4, 98304
  s_add_u32 s72, s7, 0xe0080
  buffer_load_dwordx4 v12, s[48:51], s72 offen offset:0 lds
  buffer_load_dwordx4 v13, s[48:51], s72 offen offset:1024 lds
  buffer_load_dwordx4 v14, s[48:51], s72 offen offset:2048 lds
  buffer_load_dwordx4 v15, s[48:51], s72 offen offset:3072 lds
  s_add_u32 m0, s4, 102400
  s_add_u32 s72, s7, 0xfc080
  buffer_load_dwordx4 v12, s[48:51], s72 offen offset:0 lds
  buffer_load_dwordx4 v13, s[48:51], s72 offen offset:1024 lds
  buffer_load_dwordx4 v14, s[48:51], s72 offen offset:2048 lds
  buffer_load_dwordx4 v15, s[48:51], s72 offen offset:3072 lds
  s_waitcnt lgkmcnt(0)
  s_mov_b32 exec_lo, 0x30
  s_mov_b32 exec_hi, 0x0
  buffer_load_dword v72, v70, s[52:55], 0 offen
  s_mov_b64 exec, -1
  s_waitcnt vmcnt(12)
  s_barrier
  s_mov_b32 s80, s88
  s_mov_b32 s81, 0
  s_waitcnt vmcnt(9)
  v_cmp_ne_u32 vcc, s29, v39
  s_and_b64 vcc, vcc, s[80:81]
  s_cbranch_scc0 AOK_16
PL_17:
  buffer_load_dword v39, v21, s[60:63], s89 offen sc1
  s_waitcnt vmcnt(0)
  v_cmp_ne_u32 vcc, s29, v39
  s_and_b64 vcc, vcc, s[80:81]
  s_cbranch_scc0 PD_18
  s_sub_u32 s78, s78, 1
  s_cmp_gt_i32 s78, 0
  s_cbranch_scc1 PL_17
PD_18:
AOK_16:
  s_lshl_b32 s72, s27, 16
  s_add_u32 s72, s72, 0x1200000
  buffer_load_dwordx4 v[128:131], v37, s[60:63], s72 offen sc1
  s_add_u32 s72, s72, 8192
  buffer_load_dwordx4 v[132:135], v37, s[60:63], s72 offen sc1
  s_add_u32 s72, s72, 8192
  buffer_load_dwordx4 v[136:139], v37, s[60:63], s72 offen sc1
  s_add_u32 s72, s72, 8192
  buffer_load_dwordx4 v[140:143], v37, s[60:63], s72 offen sc1
  s_add_u32 s72, s72, 8192
  buffer_load_dwordx4 v[144:147], v37, s[60:63], s72 offen sc1
  s_add_u32 s72, s72, 8192
  buffer_load_dwordx4 v[148:151], v37, s[60:63], s72 offen sc1
  s_add_u32 s72, s72, 8192
  buffer_load_dwordx4 v[152:155], v37, s[60:63], s72 offen sc1
  s_add_u32 s72, s72, 8192
  buffer_load_dwordx4 v[156:159], v37, s[60:63], s72 offen sc1
  s_add_u32 m0, s4, 0
  s_add_u32 s72, s7, 0x100
  buffer_load_dwordx4 v12, s[48:51], s72 offen offset:0 lds
  buffer_load_dwordx4 v13, s[48:51], s72 offen offset:1024 lds
  buffer_load_dwordx4 v14, s[48:51], s72 offen offset:2048 lds
  buffer_load_dwordx4 v15, s[48:51], s72 offen offset:3072 lds
  s_add_u32 m0, s4, 4096
  s_add_u32 s72, s7, 0x1c100
  buffer_load_dwordx4 v12, s[48:51], s72 offen offset:0 lds
  buffer_load_dwordx4 v13, s[48:51], s72 offen offset:1024 lds
  buffer_load_dwordx4 v14, s[48:51], s72 offen offset:2048 lds
  buffer_load_dwordx4 v15, s[48:51], s72 offen offset:3072 lds
  s_mov_b32 exec_lo, 0xc0
  s_mov_b32 exec_hi, 0x0
  buffer_load_dword v72, v70, s[52:55], 0 offen
  s_mov_b64 exec, -1
  s_waitcnt vmcnt(18)
  s_barrier
  s_add_u32 m0, s4, 32768
  s_add_u32 s72, s7, 0xe0100
  buffer_load_dwordx4 v12, s[48:51], s72 offen offset:0 lds
  buffer_load_dwordx4 v13, s[48:51], s72 offen offset:1024 lds
  buffer_load_dwordx4 v14, s[48:51], s72 offen offset:2048 lds
  buffer_load_dwordx4 v15, s[48:51], s72 offen offset:3072 lds
  s_add_u32 m0, s4, 36864
  s_add_u32 s72, s7, 0xfc100
  buffer_load_dwordx4 v12, s[48:51], s72 offen offset:0 lds
  buffer_load_dwordx4 v13, s[48:51], s72 offen offset:1024 lds
  buffer_load_dwordx4 v14, s[48:51], s72 offen offset:2048 lds
  buffer_load_dwordx4 v15, s[48:51], s72 offen offset:3072 lds
  s_waitcnt vmcnt(17)
  v_add_f32 v128, v128, v144
  v_add_f32 v129, v129, v145
  v_add_f32 v130, v130, v146
  v_add_f32 v131, v131, v147
  v_add_f32 v132, v132, v148
  v_add_f32 v133, v133, v149
  v_add_f32 v134, v134, v150
  v_add_f32 v135, v135, v151
  v_add_f32 v136, v136, v152
  v_add_f32 v137, v137, v153
  v_add_f32 v138, v138, v154
  v_add_f32 v139, v139, v155
  v_add_f32 v140, v140, v156
  v_add_f32 v141, v141, v157
  v_add_f32 v142, v142, v158
  v_add_f32 v143, v143, v159
  v_add_f32 v128, v128, v136
  v_add_f32 v129, v129, v137
  v_add_f32 v130, v130, v138
  v_add_f32 v131, v131, v139
  v_add_f32 v132, v132, v140
  v_add_f32 v133, v133, v141
  v_add_f32 v134, v134, v142
  v_add_f32 v135, v135, v143
  v_add_f32 v128, v128, v132
  v_add_f32 v129, v129, v133
  v_add_f32 v130, v130, v134
  v_add_f32 v131, v131, v135
  v_mov_b32 v132, v128
  v_mov_b32 v133, v129
  v_mov_b32 v134, v130
  v_mov_b32 v135, v131
  v_permlane32_swap_b32 v128, v132
  v_permlane32_swap_b32 v129, v133
  v_permlane32_swap_b32 v130, v134
  v_permlane32_swap_b32 v131, v135
  v_add_f32 v128, v128, v132
  v_add_f32 v129, v129, v133
  v_add_f32 v130, v130, v134
  v_add_f32 v131, v131, v135
  v_mov_b32 v132, v128
  v_mov_b32 v133, v129
  v_mov_b32 v134, v130
  v_mov_b32 v135, v131
  v_permlane16_swap_b32 v128, v132
  v_permlane16_swap_b32 v129, v133
  v_permlane16_swap_b32 v130, v134
  v_permlane16_swap_b32 v131, v135
  v_add_f32 v128, v128, v132
  v_add_f32 v129, v129, v133
  v_add_f32 v130, v130, v134
  v_add_f32 v131, v131, v135
  v_cvt_pk_bf16_f32 v136, v128, v129
  v_cvt_pk_bf16_f32 v137, v130, v131
  s_lshl_b32 s99, s27, 10
  s_add_u32 s99, s99, 0x1400000
  buffer_store_dwordx2 v[136:137], v38, s[60:63], s99 offen sc1
  s_mov_b32 exec_lo, 0x300
  s_mov_b32 exec_hi, 0x0
  buffer_load_dword v72, v70, s[52:55], 0 offen
  s_mov_b64 exec, -1
  s_waitcnt vmcnt(11)
  s_barrier
  s_add_u32 m0, s4, 65536
  s_add_u32 s72, s7, 0x180
  buffer_load_dwordx4 v12, s[48:51], s72 offen offset:0 lds
  buffer_load_dwordx4 v13, s[48:51], s72 offen offset:1024 lds
  buffer_load_dwordx4 v14, s[48:51], s72 offen offset:2048 lds
  buffer_load_dwordx4 v15, s[48:51], s72 offen offset:3072 lds
  s_add_u32 m0, s4, 69632
  s_add_u32 s72, s7, 0x1c180
  buffer_load_dwordx4 v12, s[48:51], s72 offen offset:0 lds
  buffer_load_dwordx4 v13, s[48:51], s72 offen offset:1024 lds
  buffer_load_dwordx4 v14, s[48:51], s72 offen offset:2048 lds
  buffer_load_dwordx4 v15, s[48:51], s72 offen offset:3072 lds
  s_mov_b32 exec_lo, 0xc00
  s_mov_b32 exec_hi, 0x0
  buffer_load_dword v72, v70, s[52:55], 0 offen
  s_mov_b64 exec, -1
  s_waitcnt vmcnt(11)
  s_barrier
  s_add_u32 m0, s4, 98304
  s_add_u32 s72, s7, 0xe0180
  buffer_load_dwordx4 v12, s[48:51], s72 offen offset:0 lds
  buffer_load_dwordx4 v13, s[48:51], s72 offen offset:1024 lds
  buffer_load_dwordx4 v14, s[48:51], s72 offen offset:2048 lds
  buffer_load_dwordx4 v15, s[48:51], s72 offen offset:3072 lds
  s_add_u32 m0, s4, 102400
  s_add_u32 s72, s7, 0xfc180
  buffer_load_dwordx4 v12, s[48:51], s72 offen offset:0 lds
  buffer_load_dwordx4 v13, s[48:51], s72 offen offset:1024 lds
  buffer_load_dwordx4 v14, s[48:51], s72 offen offset:2048 lds
  buffer_load_dwordx4 v15, s[48:51], s72 offen offset:3072 lds
  s_lshl_b32 s72, s27, 3
  s_add_u32 s72, s72, s28
  s_lshl_b32 s72, s72, 2
  s_add_u32 s72, s72, 0x1709000
  v_or_b32 v28, s87, v20
  s_waitcnt vmcnt(18)
  buffer_store_dword v19, v28, s[60:63], s72 offen sc1
  s_mov_b32 exec_lo, 0x3000
  s_mov_b32 exec_hi, 0x0
  buffer_load_dword v72, v70, s[52:55], 0 offen
  s_mov_b64 exec, -1
  s_mov_b32 exec_lo, 0xf
  s_mov_b32 exec_hi, 0x0
  buffer_load_dword v72, v71, s[56:59], 0 offen
  s_mov_b64 exec, -1
  s_waitcnt vmcnt(12)
  s_barrier
  s_add_u32 m0, s8, 0
  s_add_u32 s72, s10, 0x0
  buffer_load_dwordx4 v8, s[52:55], s72 offen offset:0 lds
  buffer_load_dwordx4 v9, s[52:55], s72 offen offset:1024 lds
  buffer_load_dwordx4 v10, s[52:55], s72 offen offset:2048 lds
  buffer_load_dwordx4 v11, s[52:55], s72 offen offset:3072 lds
  s_add_u32 m0, s8, 32768
  s_add_u32 s72, s10, 0x80000
  buffer_load_dwordx4 v8, s[52:55], s72 offen offset:0 lds
  buffer_load_dwordx4 v9, s[52:55], s72 offen offset:1024 lds
  buffer_load_dwordx4 v10, s[52:55], s72 offen offset:2048 lds
  buffer_load_dwordx4 v11, s[52:55], s72 offen offset:3072 lds
  s_lshl_b32 s90, s27, 7
  s_add_u32 s90, s90, 0x1703000
  buffer_load_dword v40, v21, s[60:63], s90 offen sc1
  s_waitcnt vmcnt(12)
  s_barrier
  s_waitcnt vmcnt(0)
  s_mov_b32 s80, 0xfffffff
  s_mov_b32 s81, 0x0
  v_cmp_ne_u32 vcc, s29, v40
  s_and_b64 vcc, vcc, s[80:81]
  s_cbranch_scc0 AOK_19
PL_20:
  buffer_load_dword v40, v21, s[60:63], s90 offen sc1
  s_waitcnt vmcnt(0)
  v_cmp_ne_u32 vcc, s29, v40
  s_and_b64 vcc, vcc, s[80:81]
  s_cbranch_scc0 PD_21
  s_sub_u32 s78, s78, 1
  s_cmp_gt_i32 s78, 0
  s_cbranch_scc1 PL_20
PD_21:
AOK_19:
  s_add_u32 m0, s8, 8192
  s_add_u32 s72, s12, 0x0
  buffer_load_dwordx4 v16, s[60:63], s72 offen offset:0 sc1 lds
  buffer_load_dwordx4 v16, s[60:63], s72 offen offset:1024 sc1 lds
  buffer_load_dwordx4 v16, s[60:63], s72 offen offset:2048 sc1 lds
  buffer_load_dwordx4 v16, s[60:63], s72 offen offset:3072 sc1 lds
  s_add_u32 m0, s8, 40960
  s_add_u32 s72, s12, 0x8000
  buffer_load_dwordx4 v16, s[60:63], s72 offen offset:0 sc1 lds
  buffer_load_dwordx4 v16, s[60:63], s72 offen offset:1024 sc1 lds
  buffer_load_dwordx4 v16, s[60:63], s72 offen offset:2048 sc1 lds
  buffer_load_dwordx4 v16, s[60:63], s72 offen offset:3072 sc1 lds
  s_add_u32 m0, s8, 65536
  s_add_u32 s72, s10, 0x100000
  buffer_load_dwordx4 v8, s[52:55], s72 offen offset:0 lds
  buffer_load_dwordx4 v9, s[52:55], s72 offen offset:1024 lds
  buffer_load_dwordx4 v10, s[52:55], s72 offen offset:2048 lds
  buffer_load_dwordx4 v11, s[52:55], s72 offen offset:3072 lds
  s_add_u32 m0, s8, 73728
  s_add_u32 s72, s12, 0x10000
  buffer_load_dwordx4 v16, s[60:63], s72 offen offset:0 sc1 lds
  buffer_load_dwordx4 v16, s[60:63], s72 offen offset:1024 sc1 lds
  buffer_load_dwordx4 v16, s[60:63], s72 offen offset:2048 sc1 lds
  buffer_load_dwordx4 v16, s[60:63], s72 offen offset:3072 sc1 lds
  s_waitcnt vmcnt(12)
  s_barrier
  s_lshl_b32 s91, s27, 7
  s_add_u32 s91, s91, 0x1704000
  buffer_load_dword v41, v21, s[60:63], s91 offen sc1
  s_add_u32 m0, s8, 98304
  s_add_u32 s72, s11, 0x180000
  buffer_load_dwordx4 v8, s[52:55], s72 offen offset:0 lds
  buffer_load_dwordx4 v9, s[52:55], s72 offen offset:1024 lds
  buffer_load_dwordx4 v10, s[52:55], s72 offen offset:2048 lds
  buffer_load_dwordx4 v11, s[52:55], s72 offen offset:3072 lds
  s_waitcnt vmcnt(13)
  s_barrier
  s_add_u32 m0, s8, 0
  s_add_u32 s72, s10, 0x50000
  buffer_load_dwordx4 v8, s[52:55], s72 offen offset:0 lds
  buffer_load_dwordx4 v9, s[52:55], s72 offen offset:1024 lds
  buffer_load_dwordx4 v10, s[52:55], s72 offen offset:2048 lds
  buffer_load_dwordx4 v11, s[52:55], s72 offen offset:3072 lds
  s_waitcnt vmcnt(9)
  s_barrier
  s_waitcnt vmcnt(8)
  s_mov_b32 s80, 0xfffffff
  s_mov_b32 s81, 0x0
  v_cmp_ne_u32 vcc, s29, v41
  s_and_b64 vcc, vcc, s[80:81]
  s_cbranch_scc0 AOK_22
PL_23:
  buffer_load_dword v41, v21, s[60:63], s91 offen sc1
  s_waitcnt vmcnt(0)
  v_cmp_ne_u32 vcc, s29, v41
  s_and_b64 vcc, vcc, s[80:81]
  s_cbranch_scc0 PD_24
  s_sub_u32 s78, s78, 1
  s_cmp_gt_i32 s78, 0
  s_cbranch_scc1 PL_23
PD_24:
AOK_22:
  s_add_u32 m0, s8, 106496
  s_add_u32 s72, s13, 0x18000
  buffer_load_dwordx4 v16, s[60:63], s72 offen offset:0 sc1 lds
  buffer_load_dwordx4 v16, s[60:63], s72 offen offset:1024 sc1 lds
  buffer_load_dwordx4 v16, s[60:63], s72 offen offset:2048 sc1 lds
  buffer_load_dwordx4 v16, s[60:63], s72 offen offset:3072 sc1 lds
  s_add_u32 m0, s8, 8192
  s_add_u32 s72, s12, 0x5000
  buffer_load_dwordx4 v16, s[60:63], s72 offen offset:0 sc1 lds
  buffer_load_dwordx4 v16, s[60:63], s72 offen offset:1024 sc1 lds
  buffer_load_dwordx4 v16, s[60:63], s72 offen offset:2048 sc1 lds
  buffer_load_dwordx4 v16, s[60:63], s72 offen offset:3072 sc1 lds
  s_add_u32 m0, s8, 32768
  s_add_u32 s72, s10, 0xd0000
  buffer_load_dwordx4 v8, s[52:55], s72 offen offset:0 lds
  buffer_load_dwordx4 v9, s[52:55], s72 offen offset:1024 lds
  buffer_load_dwordx4 v10, s[52:55], s72 offen offset:2048 lds
  buffer_load_dwordx4 v11, s[52:55], s72 offen offset:3072 lds
  s_add_u32 m0, s8, 40960
  s_add_u32 s72, s12, 0xd000
  buffer_load_dwordx4 v16, s[60:63], s72 offen offset:0 sc1 lds
  buffer_load_dwordx4 v16, s[60:63], s72 offen offset:1024 sc1 lds
  buffer_load_dwordx4 v16, s[60:63], s72 offen offset:2048 sc1 lds
  buffer_load_dwordx4 v16, s[60:63], s72 offen offset:3072 sc1 lds
  s_waitcnt vmcnt(12)
  s_barrier
  s_lshl_b32 s92, s27, 7
  s_add_u32 s92, s92, 0x1705000
  buffer_load_dword v42, v21, s[60:63], s92 offen sc1
  s_add_u32 m0, s8, 65536
  s_add_u32 s72, s10, 0x150000
  buffer_load_dwordx4 v8, s[52:55], s72 offen offset:0 lds
  buffer_load_dwordx4 v9, s[52:55], s72 offen offset:1024 lds
  buffer_load_dwordx4 v10, s[52:55], s72 offen offset:2048 lds
  buffer_load_dwordx4 v11, s[52:55], s72 offen offset:3072 lds
  s_add_u32 m0, s8, 73728
  s_add_u32 s72, s12, 0x15000
  buffer_load_dwordx4 v16, s[60:63], s72 offen offset:0 sc1 lds
  buffer_load_dwordx4 v16, s[60:63], s72 offen offset:1024 sc1 lds
  buffer_load_dwordx4 v16, s[60:63], s72 offen offset:2048 sc1 lds
  buffer_load_dwordx4 v16, s[60:63], s72 offen offset:3072 sc1 lds
  s_waitcnt vmcnt(17)
  s_barrier
  s_add_u32 m0, s8, 98304
  s_add_u32 s72, s10, 0x20000
  buffer_load_dwordx4 v8, s[52:55], s72 offen offset:0 lds
  buffer_load_dwordx4 v9, s[52:55], s72 offen offset:1024 lds
  buffer_load_dwordx4 v10, s[52:55], s72 offen offset:2048 lds
  buffer_load_dwordx4 v11, s[52:55], s72 offen offset:3072 lds
  s_waitcnt vmcnt(12)
  s_mov_b32 s80, 0xfffffff
  s_mov_b32 s81, 0x0
  v_cmp_ne_u32 vcc, s29, v42
  s_and_b64 vcc, vcc, s[80:81]
  s_cbranch_scc0 AOK_25
PL_26:
  buffer_load_dword v42, v21, s[60:63], s92 offen sc1
  s_waitcnt vmcnt(0)
  v_cmp_ne_u32 vcc, s29, v42
  s_and_b64 vcc, vcc, s[80:81]
  s_cbranch_scc0 PD_27
  s_sub_u32 s78, s78, 1
  s_cmp_gt_i32 s78, 0
  s_cbranch_scc1 PL_26
PD_27:
AOK_25:
  s_add_u32 m0, s8, 106496
  s_add_u32 s72, s12, 0x2000
  buffer_load_dwordx4 v16, s[60:63], s72 offen offset:0 sc1 lds
  buffer_load_dwordx4 v16, s[60:63], s72 offen offset:1024 sc1 lds
  buffer_load_dwordx4 v16, s[60:63], s72 offen offset:2048 sc1 lds
  buffer_load_dwordx4 v16, s[60:63], s72 offen offset:3072 sc1 lds
  s_barrier
  s_add_u32 m0, s8, 0
  s_add_u32 s72, s10, 0xa0000
  buffer_load_dwordx4 v8, s[52:55], s72 offen offset:0 lds
  buffer_load_dwordx4 v9, s[52:55], s72 offen offset:1024 lds
  buffer_load_dwordx4 v10, s[52:55], s72 offen offset:2048 lds
  buffer_load_dwordx4 v11, s[52:55], s72 offen offset:3072 lds
  s_add_u32 m0, s8, 8192
  s_add_u32 s72, s12, 0xa000
  buffer_load_dwordx4 v16, s[60:63], s72 offen offset:0 sc1 lds
  buffer_load_dwordx4 v16, s[60:63], s72 offen offset:1024 sc1 lds
  buffer_load_dwordx4 v16, s[60:63], s72 offen offset:2048 sc1 lds
  buffer_load_dwordx4 v16, s[60:63], s72 offen offset:3072 sc1 lds
  s_waitcnt vmcnt(16)
  s_barrier
  s_lshl_b32 s93, s27, 7
  s_add_u32 s93, s93, 0x1706000
  buffer_load_dword v43, v21, s[60:63], s93 offen sc1
  s_add_u32 m0, s8, 32768
  s_add_u32 s72, s10, 0x120000
  buffer_load_dwordx4 v8, s[52:55], s72 offen offset:0 lds
  buffer_load_dwordx4 v9, s[52:55], s72 offen offset:1024 lds
  buffer_load_dwordx4 v10, s[52:55], s72 offen offset:2048 lds
  buffer_load_dwordx4 v11, s[52:55], s72 offen offset:3072 lds
  s_add_u32 m0, s8, 40960
  s_add_u32 s72, s12, 0x12000
  buffer_load_dwordx4 v16, s[60:63], s72 offen offset:0 sc1 lds
  buffer_load_dwordx4 v16, s[60:63], s72 offen offset:1024 sc1 lds
  buffer_load_dwordx4 v16, s[60:63], s72 offen offset:2048 sc1 lds
  buffer_load_dwordx4 v16, s[60:63], s72 offen offset:3072 sc1 lds
  s_waitcnt vmcnt(17)
  s_barrier
  s_add_u32 m0, s8, 65536
  s_add_u32 s72, s11, 0x1a0000
  buffer_load_dwordx4 v8, s[52:55], s72 offen offset:0 lds
  buffer_load_dwordx4 v9, s[52:55], s72 offen offset:1024 lds
  buffer_load_dwordx4 v10, s[52:55], s72 offen offset:2048 lds
  buffer_load_dwordx4 v11, s[52:55], s72 offen offset:3072 lds
  s_waitcnt vmcnt(12)
  s_mov_b32 s80, 0xfffffff
  s_mov_b32 s81, 0x0
  v_cmp_ne_u32 vcc, s29, v43
  s_and_b64 vcc, vcc, s[80:81]
  s_cbranch_scc0 AOK_28
PL_29:
  buffer_load_dword v43, v21, s[60:63], s93 offen sc1
  s_waitcnt vmcnt(0)
  v_cmp_ne_u32 vcc, s29, v43
  s_and_b64 vcc, vcc, s[80:81]
  s_cbranch_scc0 PD_30
  s_sub_u32 s78, s78, 1
  s_cmp_gt_i32 s78, 0
  s_cbranch_scc1 PL_29
PD_30:
AOK_28:
  s_add_u32 m0, s8, 73728
  s_add_u32 s72, s13, 0x1a000
  buffer_load_dwordx4 v16, s[60:63], s72 offen offset:0 sc1 lds
  buffer_load_dwordx4 v16, s[60:63], s72 offen offset:1024 sc1 lds
  buffer_load_dwordx4 v16, s[60:63], s72 offen offset:2048 sc1 lds
  buffer_load_dwordx4 v16, s[60:63], s72 offen offset:3072 sc1 lds
  s_barrier
  s_add_u32 m0, s8, 98304
  s_add_u32 s72, s10, 0x70000
  buffer_load_dwordx4 v8, s[52:55], s72 offen offset:0 lds
  buffer_load_dwordx4 v9, s[52:55], s72 offen offset:1024 lds
  buffer_load_dwordx4 v10, s[52:55], s72 offen offset:2048 lds
  buffer_load_dwordx4 v11, s[52:55], s72 offen offset:3072 lds
  s_add_u32 m0, s8, 106496
  s_add_u32 s72, s12, 0x7000
  buffer_load_dwordx4 v16, s[60:63], s72 offen offset:0 sc1 lds
  buffer_load_dwordx4 v16, s[60:63], s72 offen offset:1024 sc1 lds
  buffer_load_dwordx4 v16, s[60:63], s72 offen offset:2048 sc1 lds
  buffer_load_dwordx4 v16, s[60:63], s72 offen offset:3072 sc1 lds
  s_waitcnt vmcnt(16)
  s_barrier
  s_add_u32 m0, s8, 0
  s_add_u32 s72, s10, 0xf0000
  buffer_load_dwordx4 v8, s[52:55], s72 offen offset:0 lds
  buffer_load_dwordx4 v9, s[52:55], s72 offen offset:1024 lds
  buffer_load_dwordx4 v10, s[52:55], s72 offen offset:2048 lds
  buffer_load_dwordx4 v11, s[52:55], s72 offen offset:3072 lds
  s_add_u32 m0, s8, 8192
  s_add_u32 s72, s12, 0xf000
  buffer_load_dwordx4 v16, s[60:63], s72 offen offset:0 sc1 lds
  buffer_load_dwordx4 v16, s[60:63], s72 offen offset:1024 sc1 lds
  buffer_load_dwordx4 v16, s[60:63], s72 offen offset:2048 sc1 lds
  buffer_load_dwordx4 v16, s[60:63], s72 offen offset:3072 sc1 lds
  s_waitcnt vmcnt(16)
  s_barrier
  s_lshl_b32 s94, s27, 7
  s_add_u32 s94, s94, 0x1707000
  buffer_load_dword v44, v21, s[60:63], s94 offen sc1
  s_add_u32 m0, s8, 32768
  s_add_u32 s72, s10, 0x170000
  buffer_load_dwordx4 v8, s[52:55], s72 offen offset:0 lds
  buffer_load_dwordx4 v9, s[52:55], s72 offen offset:1024 lds
  buffer_load_dwordx4 v10, s[52:55], s72 offen offset:2048 lds
  buffer_load_dwordx4 v11, s[52:55], s72 offen offset:3072 lds
  s_add_u32 m0, s8, 40960
  s_add_u32 s72, s12, 0x17000
  buffer_load_dwordx4 v16, s[60:63], s72 offen offset:0 sc1 lds
  buffer_load_dwordx4 v16, s[60:63], s72 offen offset:1024 sc1 lds
  buffer_load_dwordx4 v16, s[60:63], s72 offen offset:2048 sc1 lds
  buffer_load_dwordx4 v16, s[60:63], s72 offen offset:3072 sc1 lds
  s_waitcnt vmcnt(17)
  s_barrier
  s_add_u32 m0, s8, 65536
  s_add_u32 s72, s9, 0x0
  buffer_load_dwordx4 v8, s[56:59], s72 offen offset:0 lds
  buffer_load_dwordx4 v9, s[56:59], s72 offen offset:1024 lds
  buffer_load_dwordx4 v10, s[56:59], s72 offen offset:2048 lds
  buffer_load_dwordx4 v11, s[56:59], s72 offen offset:3072 lds
  s_waitcnt vmcnt(12)
  s_mov_b32 s80, 0xffffffff
  s_mov_b32 s81, 0x0
  v_cmp_ne_u32 vcc, s29, v44
  s_and_b64 vcc, vcc, s[80:81]
  s_cbranch_scc0 AOK_31
PL_32:
  buffer_load_dword v44, v21, s[60:63], s94 offen sc1
  s_waitcnt vmcnt(0)
  v_cmp_ne_u32 vcc, s29, v44
  s_and_b64 vcc, vcc, s[80:81]
  s_cbranch_scc0 PD_33
  s_sub_u32 s78, s78, 1
  s_cmp_gt_i32 s78, 0
  s_cbranch_scc1 PL_32
PD_33:
AOK_31:
  s_add_u32 m0, s8, 73728
  s_add_u32 s72, s14, 0x0
  buffer_load_dwordx4 v16, s[60:63], s72 offen offset:0 sc1 lds
  buffer_load_dwordx4 v16, s[60:63], s72 offen offset:1024 sc1 lds
  buffer_load_dwordx4 v16, s[60:63], s72 offen offset:2048 sc1 lds
  buffer_load_dwordx4 v16, s[60:63], s72 offen offset:3072 sc1 lds
  s_barrier
  s_add_u32 m0, s8, 98304
  s_add_u32 s72, s9, 0x20000
  buffer_load_dwordx4 v8, s[56:59], s72 offen offset:0 lds
  buffer_load_dwordx4 v9, s[56:59], s72 offen offset:1024 lds
  buffer_load_dwordx4 v10, s[56:59], s72 offen offset:2048 lds
  buffer_load_dwordx4 v11, s[56:59], s72 offen offset:3072 lds
  s_add_u32 m0, s8, 106496
  s_add_u32 s72, s14, 0x2000
  buffer_load_dwordx4 v16, s[60:63], s72 offen offset:0 sc1 lds
  buffer_load_dwordx4 v16, s[60:63], s72 offen offset:1024 sc1 lds
  buffer_load_dwordx4 v16, s[60:63], s72 offen offset:2048 sc1 lds
  buffer_load_dwordx4 v16, s[60:63], s72 offen offset:3072 sc1 lds
  s_waitcnt vmcnt(16)
  s_barrier
  s_add_u32 m0, s8, 0
  s_add_u32 s72, s9, 0x40000
  buffer_load_dwordx4 v8, s[56:59], s72 offen offset:0 lds
  buffer_load_dwordx4 v9, s[56:59], s72 offen offset:1024 lds
  buffer_load_dwordx4 v10, s[56:59], s72 offen offset:2048 lds
  buffer_load_dwordx4 v11, s[56:59], s72 offen offset:3072 lds
  s_add_u32 m0, s8, 8192
  s_add_u32 s72, s14, 0x4000
  buffer_load_dwordx4 v16, s[60:63], s72 offen offset:0 sc1 lds
  buffer_load_dwordx4 v16, s[60:63], s72 offen offset:1024 sc1 lds
  buffer_load_dwordx4 v16, s[60:63], s72 offen offset:2048 sc1 lds
  buffer_load_dwordx4 v16, s[60:63], s72 offen offset:3072 sc1 lds
  s_waitcnt vmcnt(16)
  s_barrier
  s_add_u32 m0, s8, 32768
  s_add_u32 s72, s9, 0x60000
  buffer_load_dwordx4 v8, s[56:59], s72 offen offset:0 lds
  buffer_load_dwordx4 v9, s[56:59], s72 offen offset:1024 lds
  buffer_load_dwordx4 v10, s[56:59], s72 offen offset:2048 lds
  buffer_load_dwordx4 v11, s[56:59], s72 offen offset:3072 lds
  s_add_u32 m0, s8, 40960
  s_add_u32 s72, s14, 0x6000
  buffer_load_dwordx4 v16, s[60:63], s72 offen offset:0 sc1 lds
  buffer_load_dwordx4 v16, s[60:63], s72 offen offset:1024 sc1 lds
  buffer_load_dwordx4 v16, s[60:63], s72 offen offset:2048 sc1 lds
  buffer_load_dwordx4 v16, s[60:63], s72 offen offset:3072 sc1 lds
  s_waitcnt vmcnt(16)
  s_barrier
  s_waitcnt vmcnt(8)
  s_barrier
  s_waitcnt vmcnt(0)
  s_barrier
  s_waitcnt vmcnt(0) lgkmcnt(0)
  s_branch P_END
P_END:
  s_endpgm
.section .rodata,"a"
.p2align 6
.amdhsa_kernel recurrent_scan__linear_attn_block__mixer_s_mlp__prompt_kernel
  .amdhsa_next_free_vgpr 256
  .amdhsa_next_free_sgpr 102
  .amdhsa_accum_offset 256
  .amdhsa_group_segment_fixed_size 0
  .amdhsa_kernarg_size 88
  .amdhsa_user_sgpr_count 2
  .amdhsa_user_sgpr_kernarg_segment_ptr 1
  .amdhsa_system_sgpr_workgroup_id_x 1
.end_amdhsa_kernel
```
